```python
import torch

def _softmax(x, axis=-1):
    return torch.softmax(x, dim=axis)
def _gelu(x):
    return torch.nn.functional.gelu(x, approximate="tanh")
def _silu(x):
    return torch.nn.functional.silu(x)
def _sigmoid(x):
    return torch.sigmoid(x)
def _layernorm(x, axis=-1, eps=1e-5):
    m = x.mean(dim=axis, keepdim=True)
    v = x.var(dim=axis, keepdim=True, unbiased=False)
    return (x - m) / torch.sqrt(v + eps)
def _scatter_add(tgt, idx, src, axis=0):
    return tgt.clone().index_add_(axis, idx, src)
def _segment_sum(src, seg, n):
    out = torch.zeros((n,) + src.shape[1:], dtype=src.dtype)
    return out.index_add_(0, seg, src)
def _pad(x, pw):
    flat = tuple(v for pair in reversed(pw) for v in pair)
    return torch.nn.functional.pad(x, flat)

kernel_name = 'gated_mix__spectral_gfnet__dense_activation_gelu__prompt'

def setup_inputs():

    _w = (lambda a: (lambda t: t.to(torch.bfloat16) if t.is_floating_point() else t)(torch.as_tensor(a)))
    def _A_setup():
        B, S, D = 1, 2048, 512
        Df = D // 2 + 1
        return {
            "x": _w((lambda *s: torch.randn(*s, dtype=torch.bfloat16) * 0.05)(B, S, D)),
            "w_r": _w((lambda *s: torch.randn(*s, dtype=torch.bfloat16) * 0.8)(S, Df) * 0.02),
            "w_i": _w((lambda *s: torch.randn(*s, dtype=torch.bfloat16) * 0.8)(S, Df) * 0.02),
        }
    _A_in = _A_setup()

    def _B_setup():
        B, S, D, F = 1, 2048, 512, 1792
        return {
            "x": _w((lambda *s: torch.randn(*s, dtype=torch.bfloat16) * 0.05)(B, S, D)),
            "w1": _w((lambda *s: torch.randn(*s, dtype=torch.bfloat16) * 3.2)(D, F) * (D ** -0.5)),
            "b1": _w((lambda *s: torch.randn(*s, dtype=torch.bfloat16) * 3.2)(F) * 0.01),
            "w2": _w((lambda *s: torch.randn(*s, dtype=torch.bfloat16) * 0.05)(F, D) * (F ** -0.5)),
            "b2": _w((lambda *s: torch.randn(*s, dtype=torch.bfloat16) * 0.1)(D) * 0.01),
        }
    _B_in = _B_setup()

    return {
        "A_x": _A_in["x"],
        "A_w_r": _A_in["w_r"],
        "A_w_i": _A_in["w_i"],
        "B_x": _B_in["x"],
        "B_w1": _B_in["w1"],
        "B_b1": _B_in["b1"],
        "B_w2": _B_in["w2"],
        "B_b2": _B_in["b2"],
        "gate_w": _w((lambda *s: torch.randn(*s, dtype=torch.bfloat16) * 0.05)(512) * 16.0),
    }

def reference(A_x, A_w_r, A_w_i, B_x, B_w1, B_b1, B_w2, B_b2, gate_w):
    def _A_ref(x, w_r, w_i):
        B, S, D = x.shape
        X = (lambda x, axes=(-2,-1): torch.fft.rfft2(x.float(), dim=axes))(x, axes=(-2, -1))
        W = w_r + 1j * w_i
        X = X * W
        y = (lambda x, s, axes=(-2,-1): torch.fft.irfft2(x, s=s, dim=axes).to(torch.bfloat16))(X, (S, D), axes=(-2, -1))
        return y

    def _B_ref(x, w1, b1, w2, b2):
        h = torch.einsum("bsd,df->bsf", x, w1) + b1
        h = _gelu(h)
        return torch.einsum("bsf,fd->bsd", h, w2) + b2

    x = A_x
    g = _sigmoid((x * gate_w).sum(-1, keepdims=True))
    a = _A_ref(x, A_w_r, A_w_i)
    b = _B_ref(x, B_w1, B_b1, B_w2, B_b2)
    return g * a + (1 - g) * b
```

```asm
; @launch grid=(256,1,1) block=(512,1,1) lds=163840
.amdgcn_target "amdgcn-amd-amdhsa--gfx950"
.text
.globl gated_mix__spectral_gfnet__dense_activation_gelu__prompt_kernel
.p2align 8
.type gated_mix__spectral_gfnet__dense_activation_gelu__prompt_kernel,@function
gated_mix__spectral_gfnet__dense_activation_gelu__prompt_kernel:
    s_cmp_ge_u32 s2, 256
    s_cbranch_scc1 L_end
    s_load_dwordx2 s[28:29], s[0:1], 0
    s_load_dwordx2 s[40:41], s[0:1], 32
    s_load_dwordx2 s[68:69], s[0:1], 88
    s_bfe_u32 s11, s2, 0x30003
    v_cmp_gt_u32 vcc, (L_codeend-gated_mix__spectral_gfnet__dense_activation_gelu__prompt_kernel)/1024+1, v0
    s_getpc_b64 s[14:15]
L_pc_2:
    s_nop 0
    s_and_saveexec_b64 s[16:17], vcc
    s_cbranch_execz L_ct_1
    s_sub_u32 s14, s14, L_pc_2-gated_mix__spectral_gfnet__dense_activation_gelu__prompt_kernel
    s_subb_u32 s15, s15, 0
    v_lshl_or_b32 v2, v0, 3, s11
    v_min_u32 v2, (L_codeend-gated_mix__spectral_gfnet__dense_activation_gelu__prompt_kernel)/128, v2
    v_lshlrev_b32 v2, 7, v2
    global_load_dword v254, v2, s[14:15]
L_ct_1:
    s_mov_b64 exec, -1
    v_lshrrev_b32 v1, 6, v0
    v_and_b32 v170, 63, v0
    v_readfirstlane_b32 s4, v1
    s_cmp_eq_u32 s11, 7
    s_nop 2
    s_cbranch_scc1 L_type2
    s_cmp_ge_u32 s4, 4
    s_cbranch_scc1 L_cons1
    s_and_b32 s5, s4, 3
    s_lshr_b32 s7, s2, 3
    s_and_b32 s8, s2, 6
    s_lshl_b32 s8, s8, 1
    s_lshr_b32 s81, s2, 6
    s_add_u32 s8, s8, s81
    s_mov_b32 s30, 2097152
    s_mov_b32 s31, 0x20000
    v_lshrrev_b32 v10, 5, v170
    v_lshlrev_b32 v10, 4, v10
    v_bfe_u32 v11, v170, 3, 2
    v_add_u32 v10, v10, v11
    v_lshlrev_b32 v10, 16, v10
    v_lshrrev_b32 v11, 4, v170
    v_and_b32 v12, 7, v170
    v_xor_b32 v12, v12, v11
    v_lshl_add_u32 v2, v12, 4, v10
    v_xor_b32 v3, 64, v2
    v_add_u32 v3, 261120, v3
    v_add_u32 v4, 522240, v2
    v_add_u32 v5, 522240, v3
    s_lshl_b32 s22, s8, 2
    s_add_u32 s22, s22, s5
    s_lshl_b32 s22, s22, 10
    s_lshl_b32 s24, s5, 12
    s_lshl_b32 s81, s81, 1
    s_add_u32 s81, s81, s11
    s_and_b32 s81, s81, 6
    s_lshl_b32 s3, s81, 7
    s_add_u32 s3, s3, s22
    s_add_u32 m0, s24, 0
    s_waitcnt lgkmcnt(0)
    buffer_load_dwordx4 v2, s[28:31], s3 offen offset:0 lds
    buffer_load_dwordx4 v3, s[28:31], s3 offen offset:1024 lds
    buffer_load_dwordx4 v4, s[28:31], s3 offen offset:2048 lds
    buffer_load_dwordx4 v5, s[28:31], s3 offen offset:3072 lds
    v_bfe_u32 v10, v170, 2, 2
    v_xor_b32 v10, v10, v11
    v_and_b32 v12, 3, v170
    v_lshl_add_u32 v10, v10, 2, v12
    v_mul_u32_u24 v11, 3584, v11
    v_lshl_add_u32 v6, v10, 4, v11
    v_add_u32 v7, 13312, v6
    v_add_u32 v8, 26624, v6
    v_add_u32 v9, 39936, v6
    s_mul_i32 s23, s5, 57344
    s_and_b32 s3, s2, 1
    s_mul_i32 s3, s3, 7
    s_add_u32 s3, s3, s11
    s_lshl_b32 s3, s3, 8
    s_add_u32 s23, s23, s3
    s_mov_b32 s42, 1835008
    s_mov_b32 s43, 0x20000
    s_mul_i32 s3, s81, 229376
    s_add_u32 s3, s3, s23
    s_add_u32 m0, s24, 16384
    s_add_u32 s81, s81, 1
    s_and_b32 s81, s81, 7
    buffer_load_dwordx4 v6, s[40:43], s3 offen offset:0 lds
    buffer_load_dwordx4 v7, s[40:43], s3 offen offset:1024 lds
    buffer_load_dwordx4 v8, s[40:43], s3 offen offset:2048 lds
    buffer_load_dwordx4 v9, s[40:43], s3 offen offset:3072 lds
    s_load_dwordx2 s[32:33], s[0:1], 8
    s_load_dwordx2 s[36:37], s[0:1], 16
    s_load_dwordx2 s[44:45], s[0:1], 40
    s_load_dwordx2 s[48:49], s[0:1], 48
    s_load_dwordx2 s[52:53], s[0:1], 56
    s_load_dwordx2 s[56:57], s[0:1], 64
    s_load_dwordx2 s[60:61], s[0:1], 72
    s_load_dwordx2 s[64:65], s[0:1], 80
    s_and_b32 s6, s2, 7
    s_and_b32 s3, s2, 1
    s_mul_i32 s25, s3, 7
    s_add_u32 s25, s25, s11
    s_add_u32 s9, s25, s3
    s_lshl_b32 s10, s8, 1
    s_add_u32 s10, s10, s3
    s_and_b32 s13, s7, 1
    s_lshl_b32 s13, s13, 1
    s_or_b32 s12, s3, s13
    s_and_b32 s13, s2, 6
    s_lshl_b32 s13, s13, 1
    s_or_b32 s12, s12, s13
    s_and_b32 s13, s7, 14
    s_lshl_b32 s13, s13, 3
    s_or_b32 s12, s12, s13
    s_sub_u32 s13, 256, s12
    s_cmp_eq_u32 s12, 0
    s_cselect_b32 s13, 128, s13
    s_cmp_ge_u32 s7, 16
    s_cselect_b32 s12, s13, s12
    s_mov_b32 s70, 23068672
    s_mov_b32 s71, 0x20000
    s_mov_b32 s34, 1052672
    s_mov_b32 s35, 0x20000
    s_mov_b32 s38, 1052672
    s_mov_b32 s39, 0x20000
    s_mov_b32 s46, 3584
    s_mov_b32 s47, 0x20000
    s_mov_b32 s50, 1835008
    s_mov_b32 s51, 0x20000
    s_mov_b32 s54, 1024
    s_mov_b32 s55, 0x20000
    s_mov_b32 s58, 1024
    s_mov_b32 s59, 0x20000
    s_mov_b32 s62, 2097152
    s_mov_b32 s63, 0x20000
    s_mov_b32 s66, 256
    s_mov_b32 s67, 0x20000
    s_waitcnt lgkmcnt(0)
    v_lshlrev_b32 v171, 4, v170
    v_lshrrev_b32 v175, 3, v170
    v_and_b32 v173, 2, v175
    v_lshlrev_b32 v173, 1, v173
    v_and_b32 v172, 7, v170
    v_xor_b32 v172, v172, v173
    v_lshlrev_b32 v172, 4, v172
    v_mul_u32_u24 v174, 8320, v175
    v_add_u32 v174, v174, v172
    v_lshl_add_u32 v172, v175, 10, v172
    v_add_u32 v173, 7168, v172
    v_add_u32 v175, 3072, v174
    s_lshl_b32 s75, s5, 11
    s_lshl_b32 s72, s5, 14
    s_lshl_b32 s3, s11, 7
    s_add_u32 s72, s72, s3
    s_and_b32 s3, s2, 1
    s_mul_i32 s15, s3, 917504
    s_add_u32 s72, s72, s15
    s_xor_b32 s15, s10, 1
    s_mul_i32 s73, s15, 230400
    s_mul_i32 s15, s3, 114688
    s_add_u32 s73, s73, s15
    s_add_u32 s73, s73, s75
    s_add_u32 s73, s73, 9437184
    s_add_u32 s0, s72, 917504
    s_add_u32 s1, s73, 114688
    s_lshr_b32 s3, s7, 3
    s_lshl_b32 s3, s3, 1
    s_add_u32 s3, s3, s11
    s_mul_i32 s3, s3, 7
    s_lshr_b32 s3, s3, 2
    s_lshr_b32 s15, s6, 1
    s_add_u32 s3, s3, s15
    s_cmp_ge_u32 s3, 14
    s_cselect_b32 s15, 14, 0
    s_sub_u32 s3, s3, s15
    s_lshl_b32 s15, s3, 16
    s_add_u32 s72, s72, s15
    s_lshl_b32 s15, s3, 13
    s_add_u32 s73, s73, s15
    s_mul_i32 s74, s5, 66560
    s_lshl_b32 s3, s10, 7
    s_add_u32 s74, s74, s3
    s_add_u32 s74, s74, 131072
    s_movk_i32 s18, 1024
    s_mov_b32 s19, 0x20000
    s_cmp_ge_u32 s5, 2
    s_cbranch_scc1 L_gw_3
    s_cmp_eq_u32 s5, 1
    s_cbranch_scc1 L_b2_4
    s_mov_b64 s[16:17], s[44:45]
    s_movk_i32 s18, 3584
    s_lshl_b32 s13, s25, 8
    s_mov_b32 m0, 139520
    s_mov_b64 exec, 0xffff
    s_branch L_go_5
L_b2_4:
    s_mov_b64 s[16:17], s[52:53]
    s_lshl_b32 s13, s11, 7
    s_mov_b32 m0, 139776
    s_mov_b64 exec, 0xff
    s_branch L_go_5
L_gw_3:
    s_mov_b64 s[16:17], s[56:57]
    s_and_b32 s13, s5, 1
    s_lshl_b32 s13, s13, 9
    s_add_u32 m0, s13, 140288
    s_mov_b64 exec, 0xffffffff
L_go_5:
    buffer_load_dwordx4 v171, s[16:19], s13 offen lds
    s_mov_b64 exec, -1
    s_lshr_b32 s13, s7, 2
    s_lshl_b32 s13, s13, 3
    s_add_u32 s13, s13, s6
    s_and_b32 s14, s7, 3
    s_lshr_b32 s15, s13, 4
    s_lshl_b32 s15, s15, 9
    s_bfe_u32 s16, s13, 0x20001
    s_lshl_b32 s16, s16, 7
    s_add_u32 s15, s15, s16
    s_bfe_u32 s16, s13, 0x10003
    s_lshl_b32 s16, s16, 4
    s_add_u32 s15, s15, s16
    s_and_b32 s16, s13, 1
    s_lshl_b32 s16, s16, 3
    s_add_u32 s15, s15, s16
    s_lshl_b32 s16, s5, 1
    s_add_u32 s15, s15, s16
    s_mul_i32 s19, s15, 514
    s_lshl_b32 s15, s14, 7
    s_add_u32 s17, s19, s15
    s_add_u32 s19, s19, 512
    s_cmp_eq_u32 s14, 3
    s_cselect_b32 s19, s19, 0x200000
    v_lshrrev_b32 v26, 5, v170
    v_or_b32 v27, s16, v26
    v_mul_u32_u24 v26, 514, v26
    v_and_b32 v28, 7, v170
    v_xor_b32 v28, v28, v27
    v_lshl_add_u32 v26, v28, 4, v26
    v_bfe_u32 v27, v170, 3, 2
    v_mul_u32_u24 v27, 16448, v27
    v_add_u32 v26, v26, v27
    v_bfe_u32 v28, v170, 2, 1
    v_mul_u32_u24 v28, 514, v28
    v_and_b32 v29, 3, v170
    v_mul_u32_u24 v29, 16448, v29
    v_add_u32 v28, v28, v29
    s_lshl_b32 s16, s5, 10
    s_lshl_b32 s3, s81, 7
    s_add_u32 s3, s3, s22
    s_add_u32 m0, s24, 32768
    s_nop 0
    buffer_load_dwordx4 v2, s[28:31], s3 offen offset:0 lds
    buffer_load_dwordx4 v3, s[28:31], s3 offen offset:1024 lds
    buffer_load_dwordx4 v4, s[28:31], s3 offen offset:2048 lds
    buffer_load_dwordx4 v5, s[28:31], s3 offen offset:3072 lds
    s_mul_i32 s3, s81, 229376
    s_add_u32 s3, s3, s23
    s_add_u32 m0, s24, 49152
    s_add_u32 s81, s81, 1
    s_and_b32 s81, s81, 7
    buffer_load_dwordx4 v6, s[40:43], s3 offen offset:0 lds
    buffer_load_dwordx4 v7, s[40:43], s3 offen offset:1024 lds
    buffer_load_dwordx4 v8, s[40:43], s3 offen offset:2048 lds
    buffer_load_dwordx4 v9, s[40:43], s3 offen offset:3072 lds
    s_add_u32 m0, s16, 147456
    s_nop 0
    buffer_load_dwordx4 v26, s[32:35], s17 offen nt lds
    s_add_u32 m0, s16, 151552
    s_lshr_b32 s3, s16, 5
    buffer_load_dwordx4 v26, s[36:39], s17 offen nt lds
    s_add_u32 m0, s3, 140032
    s_mov_b64 exec, 0xff
    buffer_load_ushort v28, s[32:35], s19 offen offset:0 lds
    s_add_u32 m0, s3, 140160
    s_nop 0
    buffer_load_ushort v28, s[36:39], s19 offen offset:0 lds
    s_mov_b64 exec, -1
    s_waitcnt vmcnt(12)
    s_barrier
    s_lshl_b32 s3, s81, 7
    s_add_u32 s3, s3, s22
    s_add_u32 m0, s24, 65536
    s_nop 0
    buffer_load_dwordx4 v2, s[28:31], s3 offen offset:0 lds
    buffer_load_dwordx4 v3, s[28:31], s3 offen offset:1024 lds
    buffer_load_dwordx4 v4, s[28:31], s3 offen offset:2048 lds
    buffer_load_dwordx4 v5, s[28:31], s3 offen offset:3072 lds
    s_mul_i32 s3, s81, 229376
    s_add_u32 s3, s3, s23
    s_add_u32 m0, s24, 81920
    s_add_u32 s81, s81, 1
    s_and_b32 s81, s81, 7
    buffer_load_dwordx4 v6, s[40:43], s3 offen offset:0 lds
    buffer_load_dwordx4 v7, s[40:43], s3 offen offset:1024 lds
    buffer_load_dwordx4 v8, s[40:43], s3 offen offset:2048 lds
    buffer_load_dwordx4 v9, s[40:43], s3 offen offset:3072 lds
    s_waitcnt vmcnt(12)
    s_barrier
    s_lshl_b32 s3, s81, 7
    s_add_u32 s3, s3, s22
    s_add_u32 m0, s24, 98304
    s_nop 0
    buffer_load_dwordx4 v2, s[28:31], s3 offen offset:0 lds
    buffer_load_dwordx4 v3, s[28:31], s3 offen offset:1024 lds
    buffer_load_dwordx4 v4, s[28:31], s3 offen offset:2048 lds
    buffer_load_dwordx4 v5, s[28:31], s3 offen offset:3072 lds
    s_mul_i32 s3, s81, 229376
    s_add_u32 s3, s3, s23
    s_add_u32 m0, s24, 114688
    s_add_u32 s81, s81, 1
    s_and_b32 s81, s81, 7
    buffer_load_dwordx4 v6, s[40:43], s3 offen offset:0 lds
    buffer_load_dwordx4 v7, s[40:43], s3 offen offset:1024 lds
    buffer_load_dwordx4 v8, s[40:43], s3 offen offset:2048 lds
    buffer_load_dwordx4 v9, s[40:43], s3 offen offset:3072 lds
    s_waitcnt vmcnt(8)
    s_barrier
    s_lshl_b32 s3, s81, 7
    s_add_u32 s3, s3, s22
    s_add_u32 m0, s24, 0
    s_nop 0
    buffer_load_dwordx4 v2, s[28:31], s3 offen offset:0 lds
    buffer_load_dwordx4 v3, s[28:31], s3 offen offset:1024 lds
    buffer_load_dwordx4 v4, s[28:31], s3 offen offset:2048 lds
    buffer_load_dwordx4 v5, s[28:31], s3 offen offset:3072 lds
    s_mul_i32 s3, s81, 229376
    s_add_u32 s3, s3, s23
    s_add_u32 m0, s24, 16384
    s_add_u32 s81, s81, 1
    s_and_b32 s81, s81, 7
    buffer_load_dwordx4 v6, s[40:43], s3 offen offset:0 lds
    buffer_load_dwordx4 v7, s[40:43], s3 offen offset:1024 lds
    buffer_load_dwordx4 v8, s[40:43], s3 offen offset:2048 lds
    buffer_load_dwordx4 v9, s[40:43], s3 offen offset:3072 lds
    s_waitcnt vmcnt(8)
    s_barrier
    s_lshl_b32 s3, s81, 7
    s_add_u32 s3, s3, s22
    s_add_u32 m0, s24, 32768
    s_nop 0
    buffer_load_dwordx4 v2, s[28:31], s3 offen offset:0 lds
    buffer_load_dwordx4 v3, s[28:31], s3 offen offset:1024 lds
    buffer_load_dwordx4 v4, s[28:31], s3 offen offset:2048 lds
    buffer_load_dwordx4 v5, s[28:31], s3 offen offset:3072 lds
    s_mul_i32 s3, s81, 229376
    s_add_u32 s3, s3, s23
    s_add_u32 m0, s24, 49152
    s_add_u32 s81, s81, 1
    s_and_b32 s81, s81, 7
    buffer_load_dwordx4 v6, s[40:43], s3 offen offset:0 lds
    buffer_load_dwordx4 v7, s[40:43], s3 offen offset:1024 lds
    buffer_load_dwordx4 v8, s[40:43], s3 offen offset:2048 lds
    buffer_load_dwordx4 v9, s[40:43], s3 offen offset:3072 lds
    s_waitcnt vmcnt(8)
    s_barrier
    s_lshl_b32 s3, s81, 7
    s_add_u32 s3, s3, s22
    s_add_u32 m0, s24, 65536
    s_nop 0
    buffer_load_dwordx4 v2, s[28:31], s3 offen offset:0 lds
    buffer_load_dwordx4 v3, s[28:31], s3 offen offset:1024 lds
    buffer_load_dwordx4 v4, s[28:31], s3 offen offset:2048 lds
    buffer_load_dwordx4 v5, s[28:31], s3 offen offset:3072 lds
    s_mul_i32 s3, s81, 229376
    s_add_u32 s3, s3, s23
    s_add_u32 m0, s24, 81920
    s_add_u32 s81, s81, 1
    s_and_b32 s81, s81, 7
    buffer_load_dwordx4 v6, s[40:43], s3 offen offset:0 lds
    buffer_load_dwordx4 v7, s[40:43], s3 offen offset:1024 lds
    buffer_load_dwordx4 v8, s[40:43], s3 offen offset:2048 lds
    buffer_load_dwordx4 v9, s[40:43], s3 offen offset:3072 lds
    s_waitcnt vmcnt(8)
    s_barrier
    s_lshl_b32 s3, s81, 7
    s_add_u32 s3, s3, s22
    s_add_u32 m0, s24, 98304
    s_nop 0
    buffer_load_dwordx4 v2, s[28:31], s3 offen offset:0 lds
    buffer_load_dwordx4 v3, s[28:31], s3 offen offset:1024 lds
    buffer_load_dwordx4 v4, s[28:31], s3 offen offset:2048 lds
    buffer_load_dwordx4 v5, s[28:31], s3 offen offset:3072 lds
    s_mul_i32 s3, s81, 229376
    s_add_u32 s3, s3, s23
    s_add_u32 m0, s24, 114688
    s_add_u32 s81, s81, 1
    s_and_b32 s81, s81, 7
    buffer_load_dwordx4 v6, s[40:43], s3 offen offset:0 lds
    buffer_load_dwordx4 v7, s[40:43], s3 offen offset:1024 lds
    buffer_load_dwordx4 v8, s[40:43], s3 offen offset:2048 lds
    buffer_load_dwordx4 v9, s[40:43], s3 offen offset:3072 lds
    s_waitcnt vmcnt(8)
    s_barrier
    s_load_dword s80, s[64:65], 0
    s_lshr_b32 s20, s5, 1
    s_lshl_b32 s20, s20, 4
    s_and_b32 s21, s9, 3
    s_lshl_b32 s21, s21, 2
    s_add_u32 s20, s20, s21
    s_and_b32 s21, s5, 1
    s_lshl_b32 s21, s21, 1
    s_add_u32 s20, s20, s21
    s_lshl_b32 s20, s20, 6
    s_lshl_b32 s21, s8, 2
    s_add_u32 s20, s20, s21
    s_lshr_b32 s21, s9, 2
    s_add_u32 s20, s20, s21
    s_lshl_b32 s20, s20, 10
    s_add_u32 s21, s20, 65536
    buffer_load_dwordx4 v[12:15], v171, s[28:31], s20 offen
    buffer_load_dwordx4 v[16:19], v171, s[28:31], s21 offen
    s_add_u32 m0, s75, 0
    s_nop 0
    buffer_load_dwordx4 v172, s[48:51], s72 offen lds
    buffer_load_dwordx4 v173, s[48:51], s72 offen offset:1024 lds
    s_add_u32 s72, s72, 65536
    s_cmp_eq_u32 s72, s0
    s_cselect_b32 s3, 917504, 0
    s_sub_u32 s72, s72, s3
    s_add_u32 m0, s75, 8192
    s_nop 0
    buffer_load_dwordx4 v172, s[48:51], s72 offen lds
    buffer_load_dwordx4 v173, s[48:51], s72 offen offset:1024 lds
    s_add_u32 s72, s72, 65536
    s_cmp_eq_u32 s72, s0
    s_cselect_b32 s3, 917504, 0
    s_sub_u32 s72, s72, s3
    s_add_u32 m0, s75, 16384
    s_nop 0
    buffer_load_dwordx4 v172, s[48:51], s72 offen lds
    buffer_load_dwordx4 v173, s[48:51], s72 offen offset:1024 lds
    s_add_u32 s72, s72, 65536
    s_cmp_eq_u32 s72, s0
    s_cselect_b32 s3, 917504, 0
    s_sub_u32 s72, s72, s3
    s_waitcnt vmcnt(8)
    s_barrier
    v_mov_b32 v165, 139264
    v_mov_b32 v166, 1
    s_cmp_gt_u32 s5, 1
    s_cbranch_scc1 L_wa_6
    s_waitcnt lgkmcnt(0)
    s_cmp_eq_u32 s80, -1
    s_cbranch_scc1 L_cc_7
    v_mov_b32 v26, 0
    s_mov_b64 exec, 0x1
    s_mov_b32 s3, 0
L_spin_8:
    buffer_load_dword v27, v26, s[64:67], 0 offen sc1
    s_add_u32 s3, s3, 1
    s_cmp_gt_u32 s3, 20000
    s_cbranch_scc1 L_spun_9
    s_waitcnt vmcnt(0)
    v_cmp_ne_u32 vcc, -1, v27
    s_nop 3
    s_cbranch_vccz L_spun_9
    s_sleep 8
    s_branch L_spin_8
L_spun_9:
    s_mov_b64 exec, -1
    s_waitcnt vmcnt(0)
L_cc_7:
    s_cmp_lg_u32 s5, 1
    s_cbranch_scc1 L_wa_6
    s_lshl_b32 s3, s14, 7
    s_mov_b32 s21, 1
    s_atomic_add s21, s[68:69], s3
    s_mov_b64 exec, 1
    ds_add_u32 v165, v166 offset:40
    s_mov_b64 exec, -1
L_wa_6:
    v_add_u32 v30, 140288, v171
    ds_read_b128 v[20:23], v30
    s_waitcnt vmcnt(6) lgkmcnt(0)
    v_dot2_f32_bf16 v30, v12, v20, 0
    v_dot2_f32_bf16 v31, v16, v20, 0
    s_nop 1
    v_dot2_f32_bf16 v30, v13, v21, v30
    v_dot2_f32_bf16 v31, v17, v21, v31
    s_nop 1
    v_dot2_f32_bf16 v30, v14, v22, v30
    v_dot2_f32_bf16 v31, v18, v22, v31
    s_nop 1
    v_dot2_f32_bf16 v30, v15, v23, v30
    v_dot2_f32_bf16 v31, v19, v23, v31
    s_nop 1
    v_add_f32_dpp v30, v30, v30 row_shr:1 row_mask:0xf bank_mask:0xf
    v_add_f32_dpp v31, v31, v31 row_shr:1 row_mask:0xf bank_mask:0xf
    s_nop 0
    v_add_f32_dpp v30, v30, v30 row_shr:2 row_mask:0xf bank_mask:0xf
    v_add_f32_dpp v31, v31, v31 row_shr:2 row_mask:0xf bank_mask:0xf
    s_nop 0
    v_add_f32_dpp v30, v30, v30 row_shr:4 row_mask:0xf bank_mask:0xf
    v_add_f32_dpp v31, v31, v31 row_shr:4 row_mask:0xf bank_mask:0xf
    s_nop 0
    v_add_f32_dpp v30, v30, v30 row_shr:8 row_mask:0xf bank_mask:0xf
    v_add_f32_dpp v31, v31, v31 row_shr:8 row_mask:0xf bank_mask:0xf
    s_nop 0
    v_add_f32_dpp v30, v30, v30 row_bcast:15 row_mask:0xa bank_mask:0xf
    v_add_f32_dpp v31, v31, v31 row_bcast:15 row_mask:0xa bank_mask:0xf
    s_nop 0
    v_add_f32_dpp v30, v30, v30 row_bcast:31 row_mask:0xc bank_mask:0xf
    v_add_f32_dpp v31, v31, v31 row_bcast:31 row_mask:0xc bank_mask:0xf
    v_mul_f32 v30, 0xbfb8aa3b, v30
    v_mul_f32 v31, 0xbfb8aa3b, v31
    v_exp_f32 v30, v30
    v_exp_f32 v31, v31
    v_add_f32 v30, 1.0, v30
    v_add_f32 v31, 1.0, v31
    v_rcp_f32 v30, v30
    v_rcp_f32 v31, v31
    s_lshl_b32 s15, s8, 4
    s_add_u32 s15, s15, s9
    s_lshl_b32 s15, s15, 2
    s_add_u32 s15, s15, s5
    s_lshl_b32 s15, s15, 3
    s_add_u32 s15, s15, 81920
    v_mov_b32 v32, 0
    s_mov_b32 exec_lo, 0
    s_mov_b32 exec_hi, 0x80000000
    buffer_store_dwordx2 v[30:31], v32, s[68:71], s15 offen sc1
    s_mov_b64 exec, -1
    s_branch L_load_common
L_type2:
    s_cmp_ge_u32 s4, 4
    s_cbranch_scc1 L_cons2
    s_and_b32 s5, s4, 3
    s_lshr_b32 s7, s2, 3
    s_and_b32 s8, s2, 6
    s_lshl_b32 s8, s8, 1
    s_lshr_b32 s81, s2, 6
    s_add_u32 s8, s8, s81
    s_mov_b32 s30, 2097152
    s_mov_b32 s31, 0x20000
    v_lshrrev_b32 v8, 3, v170
    v_lshlrev_b32 v8, 16, v8
    v_lshrrev_b32 v9, 4, v170
    v_and_b32 v10, 7, v170
    v_xor_b32 v10, v10, v9
    v_lshl_add_u32 v2, v10, 4, v8
    v_xor_b32 v3, 64, v2
    v_add_u32 v3, 1047552, v3
    v_add_u32 v4, 522240, v2
    v_add_u32 v5, 522240, v3
    s_lshl_b32 s22, s8, 2
    s_add_u32 s22, s22, s5
    s_lshl_b32 s22, s22, 10
    s_lshl_b32 s23, s5, 12
    s_waitcnt lgkmcnt(0)
    s_mov_b32 s70, 23068672
    s_mov_b32 s71, 0x20000
    s_and_b32 s6, s2, 7
    s_cmp_lg_u32 s5, 0
    s_cbranch_scc1 L_nzero_10
    s_lshr_b32 s76, s7, 3
    s_lshl_b32 s76, s76, 3
    s_add_u32 s76, s76, s6
    s_lshl_b32 s15, s76, 2
    s_add_u32 s15, s15, 192
    v_add_u32 v40, s15, v170
    s_lshl_b32 s15, s76, 1
    s_add_u32 s3, s15, 80
    v_writelane_b32 v40, s3, 4
    s_add_u32 s3, s15, 81
    v_writelane_b32 v40, s3, 5
    v_writelane_b32 v40, s6, 6
    s_lshl_b32 s3, s76, 3
    s_add_u32 s3, s3, 313
    v_add_u32 v41, s3, v170
    v_cmp_lt_u32 vcc, 6, v170
    s_nop 1
    v_cndmask_b32 v40, v40, v41, vcc
    v_lshlrev_b32 v40, 7, v40
    v_mov_b32 v44, 0
    v_mov_b32 v45, 0
    v_mov_b32 v46, 0
    v_mov_b32 v47, 0
    s_mov_b64 exec, 0x7fff
    buffer_store_dwordx4 v[44:47], v40, s[68:71], 0 offen sc1
    s_mov_b64 exec, -1
L_nzero_10:
    s_add_u32 m0, s23, 65536
    s_add_u32 s3, s22, 0
    buffer_load_dwordx4 v2, s[28:31], s3 offen offset:0 lds
    buffer_load_dwordx4 v3, s[28:31], s3 offen offset:1024 lds
    buffer_load_dwordx4 v4, s[28:31], s3 offen offset:2048 lds
    buffer_load_dwordx4 v5, s[28:31], s3 offen offset:3072 lds
    s_add_u32 m0, s23, 81920
    s_add_u32 s3, s22, 512
    buffer_load_dwordx4 v2, s[28:31], s3 offen offset:0 lds
    buffer_load_dwordx4 v3, s[28:31], s3 offen offset:1024 lds
    buffer_load_dwordx4 v4, s[28:31], s3 offen offset:2048 lds
    buffer_load_dwordx4 v5, s[28:31], s3 offen offset:3072 lds
    s_load_dwordx2 s[32:33], s[0:1], 8
    s_load_dwordx2 s[36:37], s[0:1], 16
    s_load_dwordx2 s[44:45], s[0:1], 40
    s_load_dwordx2 s[48:49], s[0:1], 48
    s_load_dwordx2 s[52:53], s[0:1], 56
    s_load_dwordx2 s[56:57], s[0:1], 64
    s_load_dwordx2 s[60:61], s[0:1], 72
    s_load_dwordx2 s[64:65], s[0:1], 80
    s_and_b32 s6, s2, 7
    s_and_b32 s3, s2, 1
    s_mul_i32 s25, s3, 7
    s_add_u32 s25, s25, s11
    s_add_u32 s9, s25, s3
    s_lshl_b32 s10, s8, 1
    s_add_u32 s10, s10, s3
    s_and_b32 s13, s7, 1
    s_lshl_b32 s13, s13, 1
    s_or_b32 s12, s3, s13
    s_and_b32 s13, s2, 6
    s_lshl_b32 s13, s13, 1
    s_or_b32 s12, s12, s13
    s_and_b32 s13, s7, 14
    s_lshl_b32 s13, s13, 3
    s_or_b32 s12, s12, s13
    s_sub_u32 s13, 256, s12
    s_cmp_eq_u32 s12, 0
    s_cselect_b32 s13, 128, s13
    s_cmp_ge_u32 s7, 16
    s_cselect_b32 s12, s13, s12
    s_mov_b32 s70, 23068672
    s_mov_b32 s71, 0x20000
    s_mov_b32 s34, 1052672
    s_mov_b32 s35, 0x20000
    s_mov_b32 s38, 1052672
    s_mov_b32 s39, 0x20000
    s_mov_b32 s46, 3584
    s_mov_b32 s47, 0x20000
    s_mov_b32 s50, 1835008
    s_mov_b32 s51, 0x20000
    s_mov_b32 s54, 1024
    s_mov_b32 s55, 0x20000
    s_mov_b32 s58, 1024
    s_mov_b32 s59, 0x20000
    s_mov_b32 s62, 2097152
    s_mov_b32 s63, 0x20000
    s_mov_b32 s66, 256
    s_mov_b32 s67, 0x20000
    s_waitcnt lgkmcnt(0)
    v_lshlrev_b32 v171, 4, v170
    v_lshrrev_b32 v175, 3, v170
    v_and_b32 v173, 2, v175
    v_lshlrev_b32 v173, 1, v173
    v_and_b32 v172, 7, v170
    v_xor_b32 v172, v172, v173
    v_lshlrev_b32 v172, 4, v172
    v_mul_u32_u24 v174, 8320, v175
    v_add_u32 v174, v174, v172
    v_lshl_add_u32 v172, v175, 10, v172
    v_add_u32 v173, 7168, v172
    v_add_u32 v175, 3072, v174
    s_lshl_b32 s75, s5, 11
    s_lshl_b32 s72, s5, 14
    s_lshl_b32 s3, s11, 7
    s_add_u32 s72, s72, s3
    s_and_b32 s3, s2, 1
    s_mul_i32 s15, s3, 917504
    s_add_u32 s72, s72, s15
    s_xor_b32 s15, s10, 1
    s_mul_i32 s73, s15, 230400
    s_mul_i32 s15, s3, 114688
    s_add_u32 s73, s73, s15
    s_add_u32 s73, s73, s75
    s_add_u32 s73, s73, 9437184
    s_add_u32 s0, s72, 917504
    s_add_u32 s1, s73, 114688
    s_lshr_b32 s3, s7, 3
    s_lshl_b32 s3, s3, 1
    s_add_u32 s3, s3, s11
    s_mul_i32 s3, s3, 7
    s_lshr_b32 s3, s3, 2
    s_lshr_b32 s15, s6, 1
    s_add_u32 s3, s3, s15
    s_cmp_ge_u32 s3, 14
    s_cselect_b32 s15, 14, 0
    s_sub_u32 s3, s3, s15
    s_lshl_b32 s15, s3, 16
    s_add_u32 s72, s72, s15
    s_lshl_b32 s15, s3, 13
    s_add_u32 s73, s73, s15
    s_mul_i32 s74, s5, 66560
    s_lshl_b32 s3, s10, 7
    s_add_u32 s74, s74, s3
    s_add_u32 s74, s74, 131072
    s_movk_i32 s18, 1024
    s_mov_b32 s19, 0x20000
    s_cmp_ge_u32 s5, 2
    s_cbranch_scc1 L_gw_11
    s_cmp_eq_u32 s5, 1
    s_cbranch_scc1 L_b2_12
    s_mov_b64 s[16:17], s[44:45]
    s_movk_i32 s18, 3584
    s_lshl_b32 s13, s25, 8
    s_mov_b32 m0, 139520
    s_mov_b64 exec, 0xffff
    s_branch L_go_13
L_b2_12:
    s_mov_b64 s[16:17], s[52:53]
    s_lshl_b32 s13, s11, 7
    s_mov_b32 m0, 139776
    s_mov_b64 exec, 0xff
    s_branch L_go_13
L_gw_11:
    s_mov_b64 s[16:17], s[56:57]
    s_and_b32 s13, s5, 1
    s_lshl_b32 s13, s13, 9
    s_add_u32 m0, s13, 140288
    s_mov_b64 exec, 0xffffffff
L_go_13:
    buffer_load_dwordx4 v171, s[16:19], s13 offen lds
    s_mov_b64 exec, -1
    s_lshr_b32 s13, s7, 2
    s_lshl_b32 s13, s13, 3
    s_add_u32 s13, s13, s6
    s_and_b32 s14, s7, 3
    s_lshr_b32 s15, s13, 4
    s_lshl_b32 s15, s15, 9
    s_bfe_u32 s16, s13, 0x20001
    s_lshl_b32 s16, s16, 7
    s_add_u32 s15, s15, s16
    s_bfe_u32 s16, s13, 0x10003
    s_lshl_b32 s16, s16, 4
    s_add_u32 s15, s15, s16
    s_and_b32 s16, s13, 1
    s_lshl_b32 s16, s16, 3
    s_add_u32 s15, s15, s16
    s_lshl_b32 s16, s5, 1
    s_add_u32 s15, s15, s16
    s_mul_i32 s19, s15, 514
    s_lshl_b32 s15, s14, 7
    s_add_u32 s17, s19, s15
    s_add_u32 s19, s19, 512
    s_cmp_eq_u32 s14, 3
    s_cselect_b32 s19, s19, 0x200000
    v_lshrrev_b32 v26, 5, v170
    v_or_b32 v27, s16, v26
    v_mul_u32_u24 v26, 514, v26
    v_and_b32 v28, 7, v170
    v_xor_b32 v28, v28, v27
    v_lshl_add_u32 v26, v28, 4, v26
    v_bfe_u32 v27, v170, 3, 2
    v_mul_u32_u24 v27, 16448, v27
    v_add_u32 v26, v26, v27
    v_bfe_u32 v28, v170, 2, 1
    v_mul_u32_u24 v28, 514, v28
    v_and_b32 v29, 3, v170
    v_mul_u32_u24 v29, 16448, v29
    v_add_u32 v28, v28, v29
    s_lshl_b32 s16, s5, 10
    s_add_u32 m0, s23, 98304
    s_add_u32 s3, s22, 128
    buffer_load_dwordx4 v2, s[28:31], s3 offen offset:0 lds
    buffer_load_dwordx4 v3, s[28:31], s3 offen offset:1024 lds
    buffer_load_dwordx4 v4, s[28:31], s3 offen offset:2048 lds
    buffer_load_dwordx4 v5, s[28:31], s3 offen offset:3072 lds
    s_add_u32 m0, s23, 114688
    s_add_u32 s3, s22, 640
    buffer_load_dwordx4 v2, s[28:31], s3 offen offset:0 lds
    buffer_load_dwordx4 v3, s[28:31], s3 offen offset:1024 lds
    buffer_load_dwordx4 v4, s[28:31], s3 offen offset:2048 lds
    buffer_load_dwordx4 v5, s[28:31], s3 offen offset:3072 lds
    s_add_u32 m0, s16, 147456
    s_nop 0
    buffer_load_dwordx4 v26, s[32:35], s17 offen nt lds
    s_add_u32 m0, s16, 151552
    s_lshr_b32 s3, s16, 5
    buffer_load_dwordx4 v26, s[36:39], s17 offen nt lds
    s_add_u32 m0, s3, 140032
    s_mov_b64 exec, 0xff
    buffer_load_ushort v28, s[32:35], s19 offen offset:0 lds
    s_add_u32 m0, s3, 140160
    s_nop 0
    buffer_load_ushort v28, s[36:39], s19 offen offset:0 lds
    s_mov_b64 exec, -1
    s_waitcnt vmcnt(13)
    s_barrier
    s_cmp_lg_u32 s5, 0
    s_cbranch_scc1 L_nconf_14
    s_lshl_b32 s76, 1, s76
    s_atomic_or s76, s[64:65], 0
L_nconf_14:
    s_waitcnt vmcnt(4)
    s_barrier
    s_add_u32 m0, s23, 65536
    s_add_u32 s3, s22, 256
    buffer_load_dwordx4 v2, s[28:31], s3 offen offset:0 lds
    buffer_load_dwordx4 v3, s[28:31], s3 offen offset:1024 lds
    buffer_load_dwordx4 v4, s[28:31], s3 offen offset:2048 lds
    buffer_load_dwordx4 v5, s[28:31], s3 offen offset:3072 lds
    s_add_u32 m0, s23, 81920
    s_add_u32 s3, s22, 768
    buffer_load_dwordx4 v2, s[28:31], s3 offen offset:0 lds
    buffer_load_dwordx4 v3, s[28:31], s3 offen offset:1024 lds
    buffer_load_dwordx4 v4, s[28:31], s3 offen offset:2048 lds
    buffer_load_dwordx4 v5, s[28:31], s3 offen offset:3072 lds
    s_waitcnt vmcnt(0)
    s_barrier
    s_add_u32 m0, s23, 98304
    s_add_u32 s3, s22, 384
    buffer_load_dwordx4 v2, s[28:31], s3 offen offset:0 lds
    buffer_load_dwordx4 v3, s[28:31], s3 offen offset:1024 lds
    buffer_load_dwordx4 v4, s[28:31], s3 offen offset:2048 lds
    buffer_load_dwordx4 v5, s[28:31], s3 offen offset:3072 lds
    s_add_u32 m0, s23, 114688
    s_add_u32 s3, s22, 896
    buffer_load_dwordx4 v2, s[28:31], s3 offen offset:0 lds
    buffer_load_dwordx4 v3, s[28:31], s3 offen offset:1024 lds
    buffer_load_dwordx4 v4, s[28:31], s3 offen offset:2048 lds
    buffer_load_dwordx4 v5, s[28:31], s3 offen offset:3072 lds
    s_lshr_b32 s20, s5, 1
    s_lshl_b32 s20, s20, 4
    s_and_b32 s21, s9, 3
    s_lshl_b32 s21, s21, 2
    s_add_u32 s20, s20, s21
    s_and_b32 s21, s5, 1
    s_lshl_b32 s21, s21, 1
    s_add_u32 s20, s20, s21
    s_lshl_b32 s20, s20, 6
    s_lshl_b32 s21, s8, 2
    s_add_u32 s20, s20, s21
    s_lshr_b32 s21, s9, 2
    s_add_u32 s20, s20, s21
    s_lshl_b32 s20, s20, 10
    s_add_u32 s21, s20, 65536
    buffer_load_dwordx4 v[12:15], v171, s[28:31], s20 offen
    buffer_load_dwordx4 v[16:19], v171, s[28:31], s21 offen
    s_waitcnt vmcnt(2)
    s_barrier
    v_add_u32 v30, 140288, v171
    ds_read_b128 v[20:23], v30
    s_waitcnt vmcnt(0) lgkmcnt(0)
    v_dot2_f32_bf16 v30, v12, v20, 0
    v_dot2_f32_bf16 v31, v16, v20, 0
    s_nop 1
    v_dot2_f32_bf16 v30, v13, v21, v30
    v_dot2_f32_bf16 v31, v17, v21, v31
    s_nop 1
    v_dot2_f32_bf16 v30, v14, v22, v30
    v_dot2_f32_bf16 v31, v18, v22, v31
    s_nop 1
    v_dot2_f32_bf16 v30, v15, v23, v30
    v_dot2_f32_bf16 v31, v19, v23, v31
    s_nop 1
    v_add_f32_dpp v30, v30, v30 row_shr:1 row_mask:0xf bank_mask:0xf
    v_add_f32_dpp v31, v31, v31 row_shr:1 row_mask:0xf bank_mask:0xf
    s_nop 0
    v_add_f32_dpp v30, v30, v30 row_shr:2 row_mask:0xf bank_mask:0xf
    v_add_f32_dpp v31, v31, v31 row_shr:2 row_mask:0xf bank_mask:0xf
    s_nop 0
    v_add_f32_dpp v30, v30, v30 row_shr:4 row_mask:0xf bank_mask:0xf
    v_add_f32_dpp v31, v31, v31 row_shr:4 row_mask:0xf bank_mask:0xf
    s_nop 0
    v_add_f32_dpp v30, v30, v30 row_shr:8 row_mask:0xf bank_mask:0xf
    v_add_f32_dpp v31, v31, v31 row_shr:8 row_mask:0xf bank_mask:0xf
    s_nop 0
    v_add_f32_dpp v30, v30, v30 row_bcast:15 row_mask:0xa bank_mask:0xf
    v_add_f32_dpp v31, v31, v31 row_bcast:15 row_mask:0xa bank_mask:0xf
    s_nop 0
    v_add_f32_dpp v30, v30, v30 row_bcast:31 row_mask:0xc bank_mask:0xf
    v_add_f32_dpp v31, v31, v31 row_bcast:31 row_mask:0xc bank_mask:0xf
    v_mul_f32 v30, 0xbfb8aa3b, v30
    v_mul_f32 v31, 0xbfb8aa3b, v31
    v_exp_f32 v30, v30
    v_exp_f32 v31, v31
    v_add_f32 v30, 1.0, v30
    v_add_f32 v31, 1.0, v31
    v_rcp_f32 v30, v30
    v_rcp_f32 v31, v31
    s_lshl_b32 s15, s8, 4
    s_add_u32 s15, s15, s9
    s_lshl_b32 s15, s15, 2
    s_add_u32 s15, s15, s5
    s_lshl_b32 s15, s15, 3
    s_add_u32 s15, s15, 81920
    v_mov_b32 v32, 0
    s_mov_b32 exec_lo, 0
    s_mov_b32 exec_hi, 0x80000000
    buffer_store_dwordx2 v[30:31], v32, s[68:71], s15 offen sc1
    s_mov_b64 exec, -1
    s_load_dword s80, s[64:65], 0
    v_mov_b32 v165, 139264
    v_mov_b32 v166, 1
    s_cmp_lg_u32 s5, 0
    s_cbranch_scc1 L_ns_17
    s_mov_b32 s3, 0
L_lw_18:
    ds_read_b32 v167, v165 offset:28
    s_add_u32 s3, s3, 1
    s_cmp_gt_u32 s3, 160000
    s_cbranch_scc1 L_lo_19
    s_waitcnt lgkmcnt(0)
    v_cmp_ne_u32 vcc, 4, v167
    s_nop 1
    s_cbranch_vccz L_lo_19
    s_sleep 2
    s_branch L_lw_18
L_lo_19:
    s_waitcnt lgkmcnt(0)
    s_cmp_eq_u32 s80, -1
    s_cbranch_scc1 L_cc_20
    v_mov_b32 v26, 0
    s_mov_b64 exec, 0x1
    s_mov_b32 s3, 0
L_spin_21:
    buffer_load_dword v27, v26, s[64:67], 0 offen sc1
    s_add_u32 s3, s3, 1
    s_cmp_gt_u32 s3, 20000
    s_cbranch_scc1 L_spun_22
    s_waitcnt vmcnt(0)
    v_cmp_ne_u32 vcc, -1, v27
    s_nop 3
    s_cbranch_vccz L_spun_22
    s_sleep 8
    s_branch L_spin_21
L_spun_22:
    s_mov_b64 exec, -1
    s_waitcnt vmcnt(0)
L_cc_20:
    s_lshl_b32 s3, s14, 7
    s_mov_b32 s21, 1
    s_atomic_add s21, s[68:69], s3
    s_mov_b32 s3, 0
L_lw_23:
    ds_read_b32 v167, v165 offset:36
    s_add_u32 s3, s3, 1
    s_cmp_gt_u32 s3, 160000
    s_cbranch_scc1 L_lo_24
    s_waitcnt lgkmcnt(0)
    v_cmp_ne_u32 vcc, 4, v167
    s_nop 1
    s_cbranch_vccz L_lo_24
    s_waitcnt lgkmcnt(0)
    s_branch L_lw_23
L_lo_24:
    s_and_b32 s13, s2, 1
    s_lshl_b32 s13, s13, 12
    s_add_u32 s13, s13, s8
    s_add_u32 s13, s13, 10240
    v_lshlrev_b32 v167, 7, v170
    s_mov_b64 exec, 0xffffffff
    buffer_store_byte v166, v167, s[68:71], s13 offen sc1
    s_mov_b64 exec, -1
    v_mov_b32 v167, 4
    s_mov_b64 exec, 1
    ds_add_u32 v165, v167 offset:32
    s_mov_b64 exec, -1
L_ns_17:
    s_cmp_eq_u32 s5, 0
    s_cbranch_scc1 L_nb_16
    s_mov_b32 s3, 0
L_lw_25:
    ds_read_b32 v167, v165 offset:32
    s_add_u32 s3, s3, 1
    s_cmp_gt_u32 s3, 160000
    s_cbranch_scc1 L_lo_26
    s_waitcnt lgkmcnt(0)
    v_cmp_ne_u32 vcc, 4, v167
    s_nop 1
    s_cbranch_vccz L_lo_26
    s_sleep 2
    s_branch L_lw_25
L_lo_26:
    s_sub_u32 s13, s5, 1
    s_lshl_b32 s14, s5, 14
    s_sub_u32 s14, s72, s14
    s_lshl_b32 s15, s13, 16
    s_add_u32 s14, s14, s15
    s_lshl_b32 s15, s5, 14
    s_sub_u32 s15, s0, s15
    s_lshl_b32 s13, s13, 13
    s_cmp_ge_u32 s14, s15
    s_cselect_b32 s3, 917504, 0
    s_sub_u32 s14, s14, s3
    s_add_u32 m0, s13, 0
    s_add_u32 s3, s14, 0
    buffer_load_dwordx4 v172, s[48:51], s3 offen lds
    buffer_load_dwordx4 v173, s[48:51], s3 offen offset:1024 lds
    s_add_u32 m0, s13, 2048
    s_add_u32 s3, s14, 16384
    buffer_load_dwordx4 v172, s[48:51], s3 offen lds
    buffer_load_dwordx4 v173, s[48:51], s3 offen offset:1024 lds
    s_add_u32 m0, s13, 4096
    s_add_u32 s3, s14, 32768
    buffer_load_dwordx4 v172, s[48:51], s3 offen lds
    buffer_load_dwordx4 v173, s[48:51], s3 offen offset:1024 lds
    s_add_u32 m0, s13, 6144
    s_add_u32 s3, s14, 49152
    buffer_load_dwordx4 v172, s[48:51], s3 offen lds
    buffer_load_dwordx4 v173, s[48:51], s3 offen offset:1024 lds
    s_add_u32 s14, s14, 196608
L_nb_16:
    s_add_u32 s72, s72, 196608
    s_cmp_ge_u32 s72, s0
    s_cselect_b32 s3, 917504, 0
    s_sub_u32 s72, s72, s3
L_load_common:
    s_sub_u32 s13, 256, s12
    s_min_u32 s13, s13, s12
    s_and_b32 s13, s13, 127
    s_and_b32 s14, s12, 1
    s_lshl_b32 s14, s14, 6
    s_lshr_b32 s15, s13, 2
    s_add_u32 s14, s14, s15
    s_cmp_gt_u32 s12, 128
    s_cselect_b32 s15, 32, 0
    s_add_u32 s14, s14, s15
    s_mul_i32 s76, s14, 16640
    s_and_b32 s13, s13, 2
    s_lshl_b32 s13, s13, 4
    s_add_u32 s76, s76, s13
    s_lshl_b32 s13, s5, 12
    s_add_u32 s76, s76, s13
    s_add_u32 s76, s76, 3145728
    s_and_b32 s13, s12, 127
    s_cmp_eq_u32 s13, 0
    s_cselect_b32 s14, 532480, 16
    s_cmp_eq_u32 s12, 128
    s_cselect_b32 s13, 16, 0
    s_add_u32 s76, s76, s13
    s_add_u32 s24, s76, s14
    s_mul_i32 s77, s12, 8320
    s_lshl_b32 s13, s5, 11
    s_add_u32 s77, s77, s13
    s_add_u32 s77, s77, 131072
    s_mul_i32 s78, s12, 8320
    s_lshl_b32 s13, s5, 10
    s_add_u32 s78, s78, s13
    s_add_u32 s78, s78, 131072
    s_cmp_eq_u32 s12, 0
    s_cselect_b32 s80, 1, 0
    v_and_b32 v160, 15, v170
    v_lshlrev_b32 v160, 8, v160
    v_bfe_u32 v167, v170, 4, 1
    v_lshl_add_u32 v160, v167, 7, v160
    v_lshrrev_b32 v167, 5, v170
    v_lshl_add_u32 v160, v167, 6, v160
    v_and_b32 v161, 0x30, v170
    v_xor_b32 v161, v161, v171
    v_xor_b32 v162, 64, v161
    v_xor_b32 v163, 0x80, v161
    v_xor_b32 v164, 0xc0, v161
    s_cmp_lg_u32 s5, 0
    s_cbranch_scc1 L_xw_30
    s_and_b32 s15, s12, 1
    s_lshl_b32 s15, s15, 2
    s_lshr_b32 s16, s6, 1
    s_add_u32 s15, s15, s16
    s_lshl_b32 s15, s15, 3
    s_lshr_b32 s16, s7, 2
    s_add_u32 s15, s15, s16
    s_add_u32 s15, s15, 80
    s_lshl_b32 s15, s15, 7
    s_mov_b32 s3, 0
L_sp_32:
    s_load_dwordx4 s[16:19], s[68:69], s15 glc
    s_add_u32 s3, s3, 1
    s_waitcnt lgkmcnt(0)
    s_cmp_gt_u32 s3, 20000
    s_cbranch_scc1 L_so_33
    s_and_b64 s[16:17], s[16:17], s[18:19]
    s_and_b32 s16, s16, s17
    s_cmp_eq_u32 s16, 0x01010101
    s_cbranch_scc1 L_so_33
    s_sleep 2
    s_branch L_sp_32
L_so_33:
    s_mov_b64 exec, 1
    ds_add_u32 v165, v166 offset:24
    s_mov_b64 exec, -1
    s_add_u32 m0, s75, 147456
    s_and_b32 s3, s12, 127
    s_cmp_eq_u32 s3, 0
    s_cbranch_scc1 L_sp_34
    s_and_b32 s13, s76, 0xffffff80
    buffer_load_dwordx4 v161, s[68:71], s13 offen sc1 lds
    buffer_load_dwordx4 v162, s[68:71], s13 offen offset:1024 sc1 lds
    s_add_u32 m0, s75, 155648
    s_add_u32 s13, s13, 2048
    buffer_load_dwordx4 v163, s[68:71], s13 offen sc1 lds
    buffer_load_dwordx4 v164, s[68:71], s13 offen offset:1024 sc1 lds
    s_branch L_sj_35
L_sp_34:
    s_sub_u32 s13, s24, 1024
    buffer_load_dwordx4 v160, s[68:71], s76 offen sc1 lds
    buffer_load_dwordx4 v160, s[68:71], s13 offen offset:1024 sc1 lds
L_sj_35:
    s_waitcnt vmcnt(0)
    s_mov_b64 exec, 1
    ds_add_u32 v165, v166 offset:0
    s_mov_b64 exec, -1
    s_mov_b32 s3, 0
L_lw_36:
    ds_read_b32 v167, v165 offset:32
    s_add_u32 s3, s3, 1
    s_cmp_gt_u32 s3, 160000
    s_cbranch_scc1 L_lo_37
    s_waitcnt lgkmcnt(0)
    v_cmp_ne_u32 vcc, 4, v167
    s_nop 1
    s_cbranch_vccz L_lo_37
    s_sleep 2
    s_branch L_lw_36
L_lo_37:
    s_branch L_xj_31
L_xw_30:
    s_mov_b32 s3, 0
L_lw_38:
    ds_read_b32 v167, v165 offset:32
    s_add_u32 s3, s3, 1
    s_cmp_gt_u32 s3, 160000
    s_cbranch_scc1 L_lo_39
    s_waitcnt lgkmcnt(0)
    v_cmp_ne_u32 vcc, 4, v167
    s_nop 1
    s_cbranch_vccz L_lo_39
    s_sleep 2
    s_branch L_lw_38
L_lo_39:
    s_lshl_b32 s3, s12, 2
    s_or_b32 s3, s3, s5
    s_cmp_lg_u32 s3, 3
    s_cbranch_scc1 L_n0_40
    s_mov_b32 s3, 0
L_lw_41:
    ds_read_b32 v167, v165 offset:40
    s_add_u32 s3, s3, 1
    s_cmp_gt_u32 s3, 160000
    s_cbranch_scc1 L_lo_42
    s_waitcnt lgkmcnt(0)
    v_cmp_ne_u32 vcc, 1, v167
    s_nop 1
    s_cbranch_vccz L_lo_42
    s_sleep 2
    s_branch L_lw_41
L_lo_42:
    s_load_dword s16, s[68:69], 0
    s_load_dword s17, s[68:69], 384
    s_movk_i32 s14, 384
    s_waitcnt lgkmcnt(0)
    s_and_b32 s16, s16, s17
    s_cmp_eq_u32 s16, 64
    s_cbranch_scc1 L_cc_43
    v_mov_b32 v168, 0
    v_writelane_b32 v168, s14, 1
    s_mov_b64 exec, 0x3
    s_mov_b32 s3, 0
L_spin_44:
    buffer_load_dword v169, v168, s[68:71], 0 offen sc1
    s_add_u32 s3, s3, 1
    s_cmp_gt_u32 s3, 20000
    s_cbranch_scc1 L_spun_45
    s_waitcnt vmcnt(0)
    v_cmp_ne_u32 vcc, 64, v169
    s_nop 3
    s_cbranch_vccz L_spun_45
    s_sleep 8
    s_branch L_spin_44
L_spun_45:
    s_mov_b64 exec, -1
    s_waitcnt vmcnt(0)
L_cc_43:
    s_mov_b32 m0, 106496
    s_mov_b32 s13, 131072
    buffer_load_dwordx4 v171, s[68:71], s13 offen offset:0 sc1 lds
    buffer_load_dwordx4 v171, s[68:71], s13 offen offset:1024 sc1 lds
    buffer_load_dwordx4 v171, s[68:71], s13 offen offset:2048 sc1 lds
    buffer_load_dwordx4 v171, s[68:71], s13 offen offset:3072 sc1 lds
    s_mov_b32 m0, 110592
    s_mov_b32 s13, 135168
    buffer_load_dwordx4 v171, s[68:71], s13 offen offset:0 sc1 lds
    buffer_load_dwordx4 v171, s[68:71], s13 offen offset:1024 sc1 lds
    buffer_load_dwordx4 v171, s[68:71], s13 offen offset:2048 sc1 lds
    buffer_load_dwordx4 v171, s[68:71], s13 offen offset:3072 sc1 lds
    s_mov_b32 m0, 98304
    s_mov_b32 s13, 2260992
    buffer_load_dwordx4 v171, s[68:71], s13 offen offset:0 sc1 lds
    buffer_load_dwordx4 v171, s[68:71], s13 offen offset:1024 sc1 lds
    buffer_load_dwordx4 v171, s[68:71], s13 offen offset:2048 sc1 lds
    buffer_load_dwordx4 v171, s[68:71], s13 offen offset:3072 sc1 lds
    s_mov_b32 m0, 102400
    s_mov_b32 s13, 2265088
    buffer_load_dwordx4 v171, s[68:71], s13 offen offset:0 sc1 lds
    buffer_load_dwordx4 v171, s[68:71], s13 offen offset:1024 sc1 lds
    buffer_load_dwordx4 v171, s[68:71], s13 offen offset:2048 sc1 lds
    buffer_load_dwordx4 v171, s[68:71], s13 offen offset:3072 sc1 lds
    s_waitcnt vmcnt(0)
    s_mov_b64 exec, 1
    ds_add_u32 v165, v166 offset:20
    s_mov_b64 exec, -1
L_n0_40:
    s_cmp_lg_u32 s5, 1
    s_cbranch_scc1 L_n2_46
    s_cmp_eq_u32 s12, 0
    s_cbranch_scc1 L_n2_46
    s_lshr_b32 s14, s12, 6
    s_lshl_b32 s14, s14, 7
    s_load_dword s16, s[68:69], s14
    s_waitcnt lgkmcnt(0)
    s_cmp_eq_u32 s16, 64
    s_cbranch_scc1 L_cc_47
    v_mov_b32 v168, s14
    s_mov_b64 exec, 0x1
    s_mov_b32 s3, 0
L_spin_48:
    buffer_load_dword v169, v168, s[68:71], 0 offen sc1
    s_add_u32 s3, s3, 1
    s_cmp_gt_u32 s3, 20000
    s_cbranch_scc1 L_spun_49
    s_waitcnt vmcnt(0)
    v_cmp_ne_u32 vcc, 64, v169
    s_nop 3
    s_cbranch_vccz L_spun_49
    s_sleep 8
    s_branch L_spin_48
L_spun_49:
    s_mov_b64 exec, -1
    s_waitcnt vmcnt(0)
L_cc_47:
    s_sub_u32 s14, s77, 2048
    s_mov_b32 m0, 106496
    s_add_u32 s13, s14, 0
    buffer_load_dwordx4 v171, s[68:71], s13 offen offset:0 sc1 lds
    buffer_load_dwordx4 v171, s[68:71], s13 offen offset:1024 sc1 lds
    buffer_load_dwordx4 v171, s[68:71], s13 offen offset:2048 sc1 lds
    buffer_load_dwordx4 v171, s[68:71], s13 offen offset:3072 sc1 lds
    s_mov_b32 m0, 110592
    s_add_u32 s13, s14, 4096
    buffer_load_dwordx4 v171, s[68:71], s13 offen offset:0 sc1 lds
    buffer_load_dwordx4 v171, s[68:71], s13 offen offset:1024 sc1 lds
    buffer_load_dwordx4 v171, s[68:71], s13 offen offset:2048 sc1 lds
    buffer_load_dwordx4 v171, s[68:71], s13 offen offset:3072 sc1 lds
L_n2_46:
    s_mov_b32 s3, 0
L_lw_50:
    ds_read_b32 v167, v165 offset:24
    s_add_u32 s3, s3, 1
    s_cmp_gt_u32 s3, 160000
    s_cbranch_scc1 L_lo_51
    s_waitcnt lgkmcnt(0)
    v_cmp_ne_u32 vcc, 1, v167
    s_nop 1
    s_cbranch_vccz L_lo_51
    s_sleep 2
    s_branch L_lw_50
L_lo_51:
    s_add_u32 m0, s75, 147456
    s_and_b32 s3, s12, 127
    s_cmp_eq_u32 s3, 0
    s_cbranch_scc1 L_sp_52
    s_and_b32 s13, s76, 0xffffff80
    buffer_load_dwordx4 v161, s[68:71], s13 offen sc1 lds
    buffer_load_dwordx4 v162, s[68:71], s13 offen offset:1024 sc1 lds
    s_add_u32 m0, s75, 155648
    s_add_u32 s13, s13, 2048
    buffer_load_dwordx4 v163, s[68:71], s13 offen sc1 lds
    buffer_load_dwordx4 v164, s[68:71], s13 offen offset:1024 sc1 lds
    s_branch L_sj_53
L_sp_52:
    s_sub_u32 s13, s24, 1024
    buffer_load_dwordx4 v160, s[68:71], s76 offen sc1 lds
    buffer_load_dwordx4 v160, s[68:71], s13 offen offset:1024 sc1 lds
L_sj_53:
    s_waitcnt vmcnt(0)
    s_mov_b64 exec, 1
    ds_add_u32 v165, v166 offset:0
    s_mov_b64 exec, -1
    s_mov_b32 s3, 0
L_lw_54:
    ds_read_b32 v167, v165 offset:0
    s_add_u32 s3, s3, 1
    s_cmp_gt_u32 s3, 160000
    s_cbranch_scc1 L_lo_55
    s_waitcnt lgkmcnt(0)
    v_cmp_ne_u32 vcc, 4, v167
    s_nop 1
    s_cbranch_vccz L_lo_55
    s_sleep 2
    s_branch L_lw_54
L_lo_55:
    s_sub_u32 s13, s5, 1
    s_lshl_b32 s14, s5, 14
    s_sub_u32 s14, s72, s14
    s_lshl_b32 s15, s13, 16
    s_add_u32 s14, s14, s15
    s_lshl_b32 s15, s5, 14
    s_sub_u32 s15, s0, s15
    s_lshl_b32 s13, s13, 13
    s_cmp_ge_u32 s14, s15
    s_cselect_b32 s3, 917504, 0
    s_sub_u32 s14, s14, s3
    s_add_u32 m0, s13, 24576
    s_add_u32 s3, s14, 0
    buffer_load_dwordx4 v172, s[48:51], s3 offen lds
    buffer_load_dwordx4 v173, s[48:51], s3 offen offset:1024 lds
    s_add_u32 m0, s13, 26624
    s_add_u32 s3, s14, 16384
    buffer_load_dwordx4 v172, s[48:51], s3 offen lds
    buffer_load_dwordx4 v173, s[48:51], s3 offen offset:1024 lds
    s_add_u32 m0, s13, 28672
    s_add_u32 s3, s14, 32768
    buffer_load_dwordx4 v172, s[48:51], s3 offen lds
    buffer_load_dwordx4 v173, s[48:51], s3 offen offset:1024 lds
    s_add_u32 m0, s13, 30720
    s_add_u32 s3, s14, 49152
    buffer_load_dwordx4 v172, s[48:51], s3 offen lds
    buffer_load_dwordx4 v173, s[48:51], s3 offen offset:1024 lds
    s_add_u32 s14, s14, 196608
L_xj_31:
    s_add_u32 s72, s72, 196608
    s_cmp_ge_u32 s72, s0
    s_cselect_b32 s3, 917504, 0
    s_sub_u32 s72, s72, s3
    s_cmp_lg_u32 s5, 0
    s_cbranch_scc1 L_hw_28
    s_lshl_b32 s13, s10, 9
    s_add_u32 s13, s13, 24576
    s_add_u32 s14, s68, s13
    s_addc_u32 s15, s69, 0
    s_mov_b32 s3, 0
L_sp_56:
    s_load_dword s16, s[14:15], 0 glc
    s_load_dword s17, s[14:15], 128 glc
    s_load_dword s18, s[14:15], 256 glc
    s_load_dword s19, s[14:15], 384 glc
    s_add_u32 s3, s3, 1
    s_waitcnt lgkmcnt(0)
    s_cmp_gt_u32 s3, 20000
    s_cbranch_scc1 L_so_57
    s_and_b64 s[16:17], s[16:17], s[18:19]
    s_and_b32 s16, s16, s17
    s_cmp_eq_u32 s16, 7
    s_cbranch_scc1 L_so_57
    s_sleep 1
    s_branch L_sp_56
L_so_57:
    s_mov_b64 exec, 1
    ds_add_u32 v165, v166 offset:12
    s_mov_b64 exec, -1
    s_branch L_hj_29
L_hw_28:
    s_mov_b32 s3, 0
L_lw_58:
    ds_read_b32 v167, v165 offset:12
    s_add_u32 s3, s3, 1
    s_cmp_gt_u32 s3, 160000
    s_cbranch_scc1 L_lo_59
    s_waitcnt lgkmcnt(0)
    v_cmp_ne_u32 vcc, 1, v167
    s_nop 1
    s_cbranch_vccz L_lo_59
    s_sleep 2
    s_branch L_lw_58
L_lo_59:
L_hj_29:
    s_add_u32 m0, s75, 114688
    s_nop 0
    buffer_load_dwordx4 v171, s[68:71], s73 offen sc1 lds
    buffer_load_dwordx4 v171, s[68:71], s73 offen offset:1024 sc1 lds
    s_add_u32 s73, s73, 8192
    s_cmp_eq_u32 s73, s1
    s_cselect_b32 s3, 114688, 0
    s_sub_u32 s73, s73, s3
    s_add_u32 m0, s75, 122880
    s_nop 0
    buffer_load_dwordx4 v171, s[68:71], s73 offen sc1 lds
    buffer_load_dwordx4 v171, s[68:71], s73 offen offset:1024 sc1 lds
    s_add_u32 s73, s73, 8192
    s_cmp_eq_u32 s73, s1
    s_cselect_b32 s3, 114688, 0
    s_sub_u32 s73, s73, s3
    s_add_u32 m0, s75, 131072
    s_nop 0
    buffer_load_dwordx4 v171, s[68:71], s73 offen sc1 lds
    buffer_load_dwordx4 v171, s[68:71], s73 offen offset:1024 sc1 lds
    s_add_u32 s73, s73, 8192
    s_cmp_eq_u32 s73, s1
    s_cselect_b32 s3, 114688, 0
    s_sub_u32 s73, s73, s3
    s_mov_b32 s3, 0
L_lw_60:
    ds_read_b32 v167, v165 offset:8
    s_add_u32 s3, s3, 1
    s_cmp_gt_u32 s3, 160000
    s_cbranch_scc1 L_lo_61
    s_waitcnt lgkmcnt(0)
    v_cmp_ne_u32 vcc, 4, v167
    s_nop 1
    s_cbranch_vccz L_lo_61
    s_sleep 1
    s_branch L_lw_60
L_lo_61:
    s_add_u32 m0, s75, 49152
    s_nop 0
    buffer_load_dwordx4 v172, s[48:51], s72 offen lds
    buffer_load_dwordx4 v173, s[48:51], s72 offen offset:1024 lds
    s_add_u32 s72, s72, 65536
    s_cmp_eq_u32 s72, s0
    s_cselect_b32 s3, 917504, 0
    s_sub_u32 s72, s72, s3
    s_add_u32 m0, s75, 57344
    s_nop 0
    buffer_load_dwordx4 v172, s[48:51], s72 offen lds
    buffer_load_dwordx4 v173, s[48:51], s72 offen offset:1024 lds
    s_add_u32 s72, s72, 65536
    s_cmp_eq_u32 s72, s0
    s_cselect_b32 s3, 917504, 0
    s_sub_u32 s72, s72, s3
    s_add_u32 m0, s75, 65536
    s_nop 0
    buffer_load_dwordx4 v172, s[48:51], s72 offen lds
    buffer_load_dwordx4 v173, s[48:51], s72 offen offset:1024 lds
    s_add_u32 s72, s72, 65536
    s_cmp_eq_u32 s72, s0
    s_cselect_b32 s3, 917504, 0
    s_sub_u32 s72, s72, s3
    s_waitcnt vmcnt(10)
    s_barrier
    s_add_u32 m0, s75, 147456
    s_nop 0
    buffer_load_dwordx4 v171, s[68:71], s73 offen sc1 lds
    buffer_load_dwordx4 v171, s[68:71], s73 offen offset:1024 sc1 lds
    s_add_u32 s73, s73, 8192
    s_cmp_eq_u32 s73, s1
    s_cselect_b32 s3, 114688, 0
    s_sub_u32 s73, s73, s3
    s_add_u32 m0, s75, 155648
    s_nop 0
    buffer_load_dwordx4 v171, s[68:71], s73 offen sc1 lds
    buffer_load_dwordx4 v171, s[68:71], s73 offen offset:1024 sc1 lds
    s_add_u32 s73, s73, 8192
    s_cmp_eq_u32 s73, s1
    s_cselect_b32 s3, 114688, 0
    s_sub_u32 s73, s73, s3
    s_add_u32 m0, s75, 73728
    s_nop 0
    buffer_load_dwordx4 v172, s[48:51], s72 offen lds
    buffer_load_dwordx4 v173, s[48:51], s72 offen offset:1024 lds
    s_add_u32 s72, s72, 65536
    s_cmp_eq_u32 s72, s0
    s_cselect_b32 s3, 917504, 0
    s_sub_u32 s72, s72, s3
    s_waitcnt vmcnt(14)
    s_barrier
    s_add_u32 m0, s75, 139264
    s_nop 0
    buffer_load_dwordx4 v171, s[68:71], s73 offen sc1 lds
    buffer_load_dwordx4 v171, s[68:71], s73 offen offset:1024 sc1 lds
    s_add_u32 s73, s73, 8192
    s_cmp_eq_u32 s73, s1
    s_cselect_b32 s3, 114688, 0
    s_sub_u32 s73, s73, s3
    s_add_u32 m0, s75, 81920
    s_nop 0
    buffer_load_dwordx4 v172, s[48:51], s72 offen lds
    buffer_load_dwordx4 v173, s[48:51], s72 offen offset:1024 lds
    s_add_u32 s72, s72, 65536
    s_cmp_eq_u32 s72, s0
    s_cselect_b32 s3, 917504, 0
    s_sub_u32 s72, s72, s3
    s_waitcnt vmcnt(16)
    s_barrier
    s_add_u32 m0, s75, 114688
    s_nop 0
    buffer_load_dwordx4 v171, s[68:71], s73 offen sc1 lds
    buffer_load_dwordx4 v171, s[68:71], s73 offen offset:1024 sc1 lds
    s_add_u32 s73, s73, 8192
    s_cmp_eq_u32 s73, s1
    s_cselect_b32 s3, 114688, 0
    s_sub_u32 s73, s73, s3
    s_add_u32 m0, s75, 90112
    s_nop 0
    buffer_load_dwordx4 v172, s[48:51], s72 offen lds
    buffer_load_dwordx4 v173, s[48:51], s72 offen offset:1024 lds
    s_add_u32 s72, s72, 65536
    s_cmp_eq_u32 s72, s0
    s_cselect_b32 s3, 917504, 0
    s_sub_u32 s72, s72, s3
    s_waitcnt vmcnt(12)
    s_barrier
    s_cmp_lg_u32 s5, 0
    s_cbranch_scc1 L_nys_62
    s_bfe_u32 s13, s2, 0x20003
    s_add_u32 s13, s13, 4
    s_lshl_b32 s3, s13, 7
    s_mov_b32 s21, 1
    s_atomic_add s21, s[68:69], s3
L_nys_62:
    s_add_u32 m0, s75, 122880
    s_nop 0
    buffer_load_dwordx4 v171, s[68:71], s73 offen sc1 lds
    buffer_load_dwordx4 v171, s[68:71], s73 offen offset:1024 sc1 lds
    s_add_u32 s73, s73, 8192
    s_cmp_eq_u32 s73, s1
    s_cselect_b32 s3, 114688, 0
    s_sub_u32 s73, s73, s3
    s_add_u32 m0, s75, 98304
    s_nop 0
    buffer_load_dwordx4 v172, s[48:51], s72 offen lds
    buffer_load_dwordx4 v173, s[48:51], s72 offen offset:1024 lds
    s_add_u32 s72, s72, 65536
    s_cmp_eq_u32 s72, s0
    s_cselect_b32 s3, 917504, 0
    s_sub_u32 s72, s72, s3
    s_waitcnt vmcnt(14)
    s_barrier
    s_add_u32 m0, s75, 131072
    s_nop 0
    buffer_load_dwordx4 v171, s[68:71], s73 offen sc1 lds
    buffer_load_dwordx4 v171, s[68:71], s73 offen offset:1024 sc1 lds
    s_add_u32 s73, s73, 8192
    s_cmp_eq_u32 s73, s1
    s_cselect_b32 s3, 114688, 0
    s_sub_u32 s73, s73, s3
    s_add_u32 m0, s75, 106496
    s_nop 0
    buffer_load_dwordx4 v172, s[48:51], s72 offen lds
    buffer_load_dwordx4 v173, s[48:51], s72 offen offset:1024 lds
    s_add_u32 s72, s72, 65536
    s_cmp_eq_u32 s72, s0
    s_cselect_b32 s3, 917504, 0
    s_sub_u32 s72, s72, s3
    s_waitcnt vmcnt(14)
    s_barrier
    s_add_u32 m0, s75, 147456
    s_nop 0
    buffer_load_dwordx4 v171, s[68:71], s73 offen sc1 lds
    buffer_load_dwordx4 v171, s[68:71], s73 offen offset:1024 sc1 lds
    s_add_u32 s73, s73, 8192
    s_cmp_eq_u32 s73, s1
    s_cselect_b32 s3, 114688, 0
    s_sub_u32 s73, s73, s3
    s_waitcnt vmcnt(12)
    s_barrier
    s_add_u32 m0, s75, 155648
    s_nop 0
    buffer_load_dwordx4 v171, s[68:71], s73 offen sc1 lds
    buffer_load_dwordx4 v171, s[68:71], s73 offen offset:1024 sc1 lds
    s_add_u32 s73, s73, 8192
    s_cmp_eq_u32 s73, s1
    s_cselect_b32 s3, 114688, 0
    s_sub_u32 s73, s73, s3
    s_waitcnt vmcnt(10)
    s_barrier
    s_add_u32 m0, s75, 139264
    s_nop 0
    buffer_load_dwordx4 v171, s[68:71], s73 offen sc1 lds
    buffer_load_dwordx4 v171, s[68:71], s73 offen offset:1024 sc1 lds
    s_add_u32 s73, s73, 8192
    s_cmp_eq_u32 s73, s1
    s_cselect_b32 s3, 114688, 0
    s_sub_u32 s73, s73, s3
    s_waitcnt vmcnt(8)
    s_barrier
    s_add_u32 m0, s75, 114688
    s_nop 0
    buffer_load_dwordx4 v171, s[68:71], s73 offen sc1 lds
    buffer_load_dwordx4 v171, s[68:71], s73 offen offset:1024 sc1 lds
    s_add_u32 s73, s73, 8192
    s_cmp_eq_u32 s73, s1
    s_cselect_b32 s3, 114688, 0
    s_sub_u32 s73, s73, s3
    s_waitcnt vmcnt(6)
    s_barrier
    s_add_u32 m0, s75, 122880
    s_nop 0
    buffer_load_dwordx4 v171, s[68:71], s73 offen sc1 lds
    buffer_load_dwordx4 v171, s[68:71], s73 offen offset:1024 sc1 lds
    s_add_u32 s73, s73, 8192
    s_cmp_eq_u32 s73, s1
    s_cselect_b32 s3, 114688, 0
    s_sub_u32 s73, s73, s3
    s_waitcnt vmcnt(6)
    s_barrier
    s_bitcmp1_b32 s2, 0
    s_cselect_b32 s3, 1, -1
    s_mul_i32 s3, s3, 230400
    s_add_u32 s73, s73, s3
    s_add_u32 s1, s1, s3
    s_add_u32 m0, s75, 131072
    s_nop 0
    buffer_load_dwordx4 v171, s[68:71], s73 offen sc1 lds
    buffer_load_dwordx4 v171, s[68:71], s73 offen offset:1024 sc1 lds
    s_add_u32 s73, s73, 8192
    s_cmp_eq_u32 s73, s1
    s_cselect_b32 s3, 114688, 0
    s_sub_u32 s73, s73, s3
    s_waitcnt vmcnt(6)
    s_barrier
    s_add_u32 m0, s75, 147456
    s_nop 0
    buffer_load_dwordx4 v171, s[68:71], s73 offen sc1 lds
    buffer_load_dwordx4 v171, s[68:71], s73 offen offset:1024 sc1 lds
    s_add_u32 s73, s73, 8192
    s_cmp_eq_u32 s73, s1
    s_cselect_b32 s3, 114688, 0
    s_sub_u32 s73, s73, s3
    s_waitcnt vmcnt(6)
    s_barrier
    s_add_u32 m0, s75, 155648
    s_nop 0
    buffer_load_dwordx4 v171, s[68:71], s73 offen sc1 lds
    buffer_load_dwordx4 v171, s[68:71], s73 offen offset:1024 sc1 lds
    s_add_u32 s73, s73, 8192
    s_cmp_eq_u32 s73, s1
    s_cselect_b32 s3, 114688, 0
    s_sub_u32 s73, s73, s3
    s_waitcnt vmcnt(6)
    s_barrier
    s_add_u32 m0, s75, 139264
    s_nop 0
    buffer_load_dwordx4 v171, s[68:71], s73 offen sc1 lds
    buffer_load_dwordx4 v171, s[68:71], s73 offen offset:1024 sc1 lds
    s_add_u32 s73, s73, 8192
    s_cmp_eq_u32 s73, s1
    s_cselect_b32 s3, 114688, 0
    s_sub_u32 s73, s73, s3
    s_waitcnt vmcnt(6)
    s_barrier
    s_add_u32 m0, s75, 114688
    s_nop 0
    buffer_load_dwordx4 v171, s[68:71], s73 offen sc1 lds
    buffer_load_dwordx4 v171, s[68:71], s73 offen offset:1024 sc1 lds
    s_add_u32 s73, s73, 8192
    s_cmp_eq_u32 s73, s1
    s_cselect_b32 s3, 114688, 0
    s_sub_u32 s73, s73, s3
    s_waitcnt vmcnt(6)
    s_barrier
    s_add_u32 m0, s75, 122880
    s_nop 0
    buffer_load_dwordx4 v171, s[68:71], s73 offen sc1 lds
    buffer_load_dwordx4 v171, s[68:71], s73 offen offset:1024 sc1 lds
    s_add_u32 s73, s73, 8192
    s_cmp_eq_u32 s73, s1
    s_cselect_b32 s3, 114688, 0
    s_sub_u32 s73, s73, s3
    s_waitcnt vmcnt(6)
    s_barrier
    s_add_u32 m0, s75, 131072
    s_nop 0
    buffer_load_dwordx4 v171, s[68:71], s73 offen sc1 lds
    buffer_load_dwordx4 v171, s[68:71], s73 offen offset:1024 sc1 lds
    s_add_u32 s73, s73, 8192
    s_cmp_eq_u32 s73, s1
    s_cselect_b32 s3, 114688, 0
    s_sub_u32 s73, s73, s3
    s_waitcnt vmcnt(6)
    s_barrier
    s_add_u32 m0, s75, 147456
    s_nop 0
    buffer_load_dwordx4 v171, s[68:71], s73 offen sc1 lds
    buffer_load_dwordx4 v171, s[68:71], s73 offen offset:1024 sc1 lds
    s_add_u32 s73, s73, 8192
    s_cmp_eq_u32 s73, s1
    s_cselect_b32 s3, 114688, 0
    s_sub_u32 s73, s73, s3
    s_waitcnt vmcnt(6)
    s_barrier
    s_add_u32 m0, s75, 155648
    s_nop 0
    buffer_load_dwordx4 v171, s[68:71], s73 offen sc1 lds
    buffer_load_dwordx4 v171, s[68:71], s73 offen offset:1024 sc1 lds
    s_add_u32 s73, s73, 8192
    s_cmp_eq_u32 s73, s1
    s_cselect_b32 s3, 114688, 0
    s_sub_u32 s73, s73, s3
    s_waitcnt vmcnt(6)
    s_barrier
    s_cmp_lg_u32 s5, 0
    s_cbranch_scc1 L_pl_63
    s_load_dword s16, s[68:69], 512
    s_load_dword s17, s[68:69], 640
    s_load_dword s18, s[68:69], 768
    s_load_dword s19, s[68:69], 896
L_pl_63:
    s_add_u32 m0, s75, 139264
    s_nop 0
    buffer_load_dwordx4 v171, s[68:71], s73 offen sc1 lds
    buffer_load_dwordx4 v171, s[68:71], s73 offen offset:1024 sc1 lds
    s_add_u32 s73, s73, 8192
    s_cmp_eq_u32 s73, s1
    s_cselect_b32 s3, 114688, 0
    s_sub_u32 s73, s73, s3
    s_waitcnt vmcnt(6)
    s_barrier
    s_add_u32 m0, s75, 114688
    s_nop 0
    buffer_load_dwordx4 v171, s[68:71], s73 offen sc1 lds
    buffer_load_dwordx4 v171, s[68:71], s73 offen offset:1024 sc1 lds
    s_add_u32 s73, s73, 8192
    s_cmp_eq_u32 s73, s1
    s_cselect_b32 s3, 114688, 0
    s_sub_u32 s73, s73, s3
    s_waitcnt vmcnt(6)
    s_barrier
    s_cmp_lg_u32 s5, 0
    s_cbranch_scc1 L_nys_64
    s_xor_b32 s13, s2, 1
    s_add_u32 s13, s13, 320
    s_lshl_b32 s3, s13, 7
    s_mov_b32 s21, 1
    s_atomic_add s21, s[68:69], s3
L_nys_64:
    s_add_u32 m0, s75, 122880
    s_nop 0
    buffer_load_dwordx4 v171, s[68:71], s73 offen sc1 lds
    buffer_load_dwordx4 v171, s[68:71], s73 offen offset:1024 sc1 lds
    s_add_u32 s73, s73, 8192
    s_cmp_eq_u32 s73, s1
    s_cselect_b32 s3, 114688, 0
    s_sub_u32 s73, s73, s3
    s_waitcnt vmcnt(6)
    s_barrier
    s_add_u32 m0, s75, 131072
    s_nop 0
    buffer_load_dwordx4 v171, s[68:71], s73 offen sc1 lds
    buffer_load_dwordx4 v171, s[68:71], s73 offen offset:1024 sc1 lds
    s_add_u32 s73, s73, 8192
    s_cmp_eq_u32 s73, s1
    s_cselect_b32 s3, 114688, 0
    s_sub_u32 s73, s73, s3
    s_waitcnt vmcnt(6)
    s_barrier
    s_add_u32 m0, s75, 147456
    s_nop 0
    buffer_load_dwordx4 v171, s[68:71], s73 offen sc1 lds
    buffer_load_dwordx4 v171, s[68:71], s73 offen offset:1024 sc1 lds
    s_add_u32 s73, s73, 8192
    s_cmp_eq_u32 s73, s1
    s_cselect_b32 s3, 114688, 0
    s_sub_u32 s73, s73, s3
    s_waitcnt vmcnt(6)
    s_cmp_lg_u32 s5, 0
    s_cbranch_scc1 L_ck_65
    s_waitcnt lgkmcnt(0)
    s_and_b64 s[16:17], s[16:17], s[18:19]
    s_and_b32 s16, s16, s17
    s_cmp_eq_u32 s16, 64
    s_cbranch_scc1 L_yok_66
    v_add_u32 v168, 4, v170
    v_lshlrev_b32 v168, 7, v168
    s_mov_b64 exec, 0xf
    s_mov_b32 s3, 0
L_spin_67:
    buffer_load_dword v167, v168, s[68:71], 0 offen sc1
    s_add_u32 s3, s3, 1
    s_cmp_gt_u32 s3, 20000
    s_cbranch_scc1 L_spun_68
    s_waitcnt vmcnt(0)
    v_cmp_ne_u32 vcc, 64, v167
    s_nop 3
    s_cbranch_vccz L_spun_68
    s_sleep 4
    s_branch L_spin_67
L_spun_68:
    s_mov_b64 exec, -1
    s_waitcnt vmcnt(0)
L_yok_66:
L_ck_65:
    s_barrier
    s_add_u32 m0, s75, 155648
    s_nop 0
    buffer_load_dwordx4 v174, s[68:71], s74 offen sc1 lds
    buffer_load_dwordx4 v175, s[68:71], s74 offen offset:1024 sc1 lds
    s_add_u32 s74, s74, 266240
    s_waitcnt vmcnt(6)
    s_barrier
    s_add_u32 m0, s75, 139264
    s_nop 0
    buffer_load_dwordx4 v174, s[68:71], s74 offen sc1 lds
    buffer_load_dwordx4 v175, s[68:71], s74 offen offset:1024 sc1 lds
    s_add_u32 s74, s74, 266240
    s_waitcnt vmcnt(6)
    s_barrier
    s_add_u32 m0, s75, 114688
    s_nop 0
    buffer_load_dwordx4 v174, s[68:71], s74 offen sc1 lds
    buffer_load_dwordx4 v175, s[68:71], s74 offen offset:1024 sc1 lds
    s_add_u32 s74, s74, 266240
    s_waitcnt vmcnt(6)
    s_barrier
    s_cmp_lg_u32 s5, 0
    s_cbranch_scc1 L_pl_69
    s_add_u32 s14, s2, 320
    s_lshl_b32 s14, s14, 7
    s_load_dword s16, s[68:69], s14 glc
L_pl_69:
    s_add_u32 m0, s75, 122880
    s_nop 0
    buffer_load_dwordx4 v174, s[68:71], s74 offen sc1 lds
    buffer_load_dwordx4 v175, s[68:71], s74 offen offset:1024 sc1 lds
    s_add_u32 s74, s74, 266240
    s_waitcnt vmcnt(6)
    s_barrier
    s_add_u32 m0, s75, 131072
    s_nop 0
    buffer_load_dwordx4 v174, s[68:71], s74 offen sc1 lds
    buffer_load_dwordx4 v175, s[68:71], s74 offen offset:1024 sc1 lds
    s_add_u32 s74, s74, 266240
    s_waitcnt vmcnt(6)
    s_barrier
    s_add_u32 m0, s75, 147456
    s_nop 0
    buffer_load_dwordx4 v174, s[68:71], s74 offen sc1 lds
    buffer_load_dwordx4 v175, s[68:71], s74 offen offset:1024 sc1 lds
    s_add_u32 s74, s74, 266240
    s_waitcnt vmcnt(6)
    s_barrier
    s_add_u32 m0, s75, 155648
    s_nop 0
    buffer_load_dwordx4 v174, s[68:71], s74 offen sc1 lds
    buffer_load_dwordx4 v175, s[68:71], s74 offen offset:1024 sc1 lds
    s_add_u32 s74, s74, 266240
    s_waitcnt vmcnt(6)
    s_barrier
    s_add_u32 m0, s75, 139264
    s_nop 0
    buffer_load_dwordx4 v174, s[68:71], s74 offen sc1 lds
    buffer_load_dwordx4 v175, s[68:71], s74 offen offset:1024 sc1 lds
    s_add_u32 s74, s74, 266240
    s_waitcnt vmcnt(6)
    s_cmp_lg_u32 s5, 0
    s_cbranch_scc1 L_ck_70
    s_waitcnt lgkmcnt(0)
    s_cmp_eq_u32 s16, 1
    s_cbranch_scc1 L_pok_71
    s_mov_b32 s3, 0
L_sp_72:
    s_load_dword s16, s[68:69], s14 glc
    s_add_u32 s3, s3, 1
    s_waitcnt lgkmcnt(0)
    s_cmp_gt_u32 s3, 20000
    s_cbranch_scc1 L_so_73
    s_cmp_eq_u32 s16, 1
    s_cbranch_scc1 L_so_73
    s_sleep 1
    s_branch L_sp_72
L_so_73:
L_pok_71:
L_ck_70:
    s_barrier
    s_waitcnt vmcnt(4)
    s_barrier
    s_waitcnt vmcnt(2)
    s_barrier
    s_waitcnt vmcnt(0)
    s_barrier
    s_endpgm
L_cons1:
    s_and_b32 s5, s4, 3
    s_lshr_b32 s7, s2, 3
    s_and_b32 s8, s2, 6
    s_lshl_b32 s8, s8, 1
    s_lshr_b32 s81, s2, 6
    s_add_u32 s8, s8, s81
    s_mov_b32 s30, 2097152
    s_mov_b32 s31, 0x20000
    s_load_dwordx2 s[32:33], s[0:1], 8
    s_load_dwordx2 s[36:37], s[0:1], 16
    s_load_dwordx2 s[44:45], s[0:1], 40
    s_load_dwordx2 s[48:49], s[0:1], 48
    s_load_dwordx2 s[52:53], s[0:1], 56
    s_load_dwordx2 s[56:57], s[0:1], 64
    s_load_dwordx2 s[60:61], s[0:1], 72
    s_load_dwordx2 s[64:65], s[0:1], 80
    s_and_b32 s6, s2, 7
    s_and_b32 s3, s2, 1
    s_mul_i32 s25, s3, 7
    s_add_u32 s25, s25, s11
    s_add_u32 s9, s25, s3
    s_lshl_b32 s10, s8, 1
    s_add_u32 s10, s10, s3
    s_and_b32 s13, s7, 1
    s_lshl_b32 s13, s13, 1
    s_or_b32 s12, s3, s13
    s_and_b32 s13, s2, 6
    s_lshl_b32 s13, s13, 1
    s_or_b32 s12, s12, s13
    s_and_b32 s13, s7, 14
    s_lshl_b32 s13, s13, 3
    s_or_b32 s12, s12, s13
    s_sub_u32 s13, 256, s12
    s_cmp_eq_u32 s12, 0
    s_cselect_b32 s13, 128, s13
    s_cmp_ge_u32 s7, 16
    s_cselect_b32 s12, s13, s12
    s_mov_b32 s70, 23068672
    s_mov_b32 s71, 0x20000
    s_mov_b32 s34, 1052672
    s_mov_b32 s35, 0x20000
    s_mov_b32 s38, 1052672
    s_mov_b32 s39, 0x20000
    s_mov_b32 s46, 3584
    s_mov_b32 s47, 0x20000
    s_mov_b32 s50, 1835008
    s_mov_b32 s51, 0x20000
    s_mov_b32 s54, 1024
    s_mov_b32 s55, 0x20000
    s_mov_b32 s58, 1024
    s_mov_b32 s59, 0x20000
    s_mov_b32 s62, 2097152
    s_mov_b32 s63, 0x20000
    s_mov_b32 s66, 256
    s_mov_b32 s67, 0x20000
    s_cmp_lg_u32 s5, 1
    s_cbranch_scc1 L_nopf_74
    v_lshlrev_b32 v2, 2, v170
    v_mov_b32 v3, 0
    v_add_u32 v2, 139264, v2
    ds_write_b32 v2, v3
L_nopf_74:
    s_lshr_b32 s22, s5, 1
    s_and_b32 s23, s5, 1
    v_lshrrev_b32 v136, 5, v170
    v_lshlrev_b32 v137, 1, v170
    v_mov_b32 v64, 0
    v_mov_b32 v65, 0
    v_mov_b32 v66, 0
    v_mov_b32 v67, 0
    v_mov_b32 v68, 0
    v_mov_b32 v69, 0
    v_mov_b32 v72, 0x3f803f80
    v_mov_b32 v73, 0x3f803f80
    v_mov_b32 v74, 0x3f803f80
    v_mov_b32 v75, 0x3f803f80
    s_lshl_b32 s13, s23, 7
    s_add_u32 s13, s13, 139520
    v_add_u32 v79, s13, v137
    v_and_b32 v137, 31, v170
    v_bfe_u32 v138, v170, 1, 3
    v_xor_b32 v138, v138, v136
    v_lshlrev_b32 v138, 4, v138
    v_lshl_add_u32 v128, v137, 7, v138
    s_lshl_b32 s13, s22, 13
    v_add_u32 v128, s13, v128
    v_xor_b32 v129, 32, v128
    v_xor_b32 v130, 64, v128
    v_xor_b32 v131, 96, v128
    v_bfe_u32 v137, v170, 2, 2
    v_lshl_add_u32 v138, v136, 3, v137
    v_lshlrev_b32 v138, 8, v138
    s_lshl_b32 s13, s23, 1
    v_xor_b32 v137, s13, v137
    v_lshl_add_u32 v138, v137, 6, v138
    v_bfe_u32 v137, v170, 4, 1
    v_lshl_add_u32 v138, v137, 5, v138
    v_and_b32 v137, 3, v170
    v_lshl_add_u32 v138, v137, 3, v138
    v_add_u32 v132, 16384, v138
    v_xor_b32 v133, 64, v132
    s_lshr_b32 s13, s7, 2
    s_lshl_b32 s13, s13, 3
    s_add_u32 s13, s13, s6
    s_and_b32 s14, s7, 3
    v_and_b32 v137, 7, v170
    s_lshl_b32 s15, s5, 1
    v_xor_b32 v136, s15, v137
    v_lshlrev_b32 v136, 4, v136
    v_lshl_add_u32 v136, v137, 9, v136
    v_lshrrev_b32 v138, 3, v170
    v_lshl_add_u32 v136, v138, 1, v136
    v_mul_u32_u24 v138, 8320, v138
    v_lshl_add_u32 v138, v137, 4, v138
    v_add_u32 v136, 147456, v136
    v_xor_b32 v137, 16, v136
    s_lshl_b32 s15, s14, 2
    s_add_u32 s15, s15, s5
    s_mul_i32 s15, s15, 133120
    s_lshl_b32 s75, s13, 7
    s_add_u32 s15, s15, s75
    s_add_u32 s72, s15, 131072
    s_add_u32 s73, s72, 66560
    s_lshl_b32 s15, s5, 2
    s_or_b32 s15, s15, s14
    s_add_u32 s74, s75, 2260992
    s_cmp_eq_u32 s15, 3
    s_cselect_b32 s74, s74, 23068672
    v_and_b32 v139, 31, v170
    v_lshlrev_b32 v139, 2, v139
    v_add_u32 v140, 140032, v139
    s_sub_u32 s13, 256, s12
    s_min_u32 s13, s13, s12
    s_and_b32 s13, s13, 127
    s_and_b32 s14, s12, 1
    s_lshl_b32 s14, s14, 6
    s_lshr_b32 s15, s13, 2
    s_add_u32 s14, s14, s15
    s_cmp_gt_u32 s12, 128
    s_cselect_b32 s15, 32, 0
    s_add_u32 s14, s14, s15
    s_mul_i32 s76, s14, 16640
    s_and_b32 s13, s13, 2
    s_lshl_b32 s13, s13, 4
    s_add_u32 s76, s76, s13
    s_lshl_b32 s13, s5, 12
    s_add_u32 s76, s76, s13
    s_add_u32 s76, s76, 3145728
    s_and_b32 s13, s12, 127
    s_cmp_eq_u32 s13, 0
    s_cselect_b32 s14, 532480, 16
    s_cmp_eq_u32 s12, 128
    s_cselect_b32 s13, 16, 0
    s_add_u32 s76, s76, s13
    s_add_u32 s24, s76, s14
    s_mul_i32 s77, s12, 8320
    s_lshl_b32 s13, s5, 11
    s_add_u32 s77, s77, s13
    s_add_u32 s77, s77, 131072
    s_mul_i32 s78, s12, 8320
    s_lshl_b32 s13, s5, 10
    s_add_u32 s78, s78, s13
    s_add_u32 s78, s78, 131072
    s_cmp_eq_u32 s12, 0
    s_cselect_b32 s80, 1, 0
    s_call_b64 s[26:27], L_fconst
    s_waitcnt lgkmcnt(0)
    s_barrier
    s_mov_b64 exec, 0xffffffff
    ds_read_u16 v64, v79
    ds_read_u16 v69, v79 offset:64
    s_mov_b64 exec, -1
    ds_read_b128 v[96:99], v128 offset:0
    ds_read_b64_tr_b16 v[104:105], v132 offset:0
    ds_read_b64_tr_b16 v[106:107], v132 offset:1024
    ds_read_b128 v[100:103], v128 offset:4096
    ds_read_b64_tr_b16 v[108:109], v133 offset:0
    ds_read_b64_tr_b16 v[110:111], v133 offset:1024
    s_waitcnt lgkmcnt(6)
    v_mfma_f32_32x32x16_bf16 v[0:15], v[64:67], v[72:75], 0
    v_mfma_f32_32x32x16_bf16 v[16:31], v[64:67], v[72:75], 0
    v_mfma_f32_32x32x16_bf16 v[32:47], v[66:69], v[72:75], 0
    v_mfma_f32_32x32x16_bf16 v[48:63], v[66:69], v[72:75], 0
    s_waitcnt lgkmcnt(0)
    v_mfma_f32_32x32x16_bf16 v[0:15], v[104:107], v[96:99], v[0:15]
    ds_read_b128 v[112:115], v129 offset:0
    ds_read_b64_tr_b16 v[120:121], v132 offset:4096
    ds_read_b64_tr_b16 v[122:123], v132 offset:5120
    v_mfma_f32_32x32x16_bf16 v[16:31], v[104:107], v[100:103], v[16:31]
    ds_read_b128 v[116:119], v129 offset:4096
    ds_read_b64_tr_b16 v[124:125], v133 offset:4096
    ds_read_b64_tr_b16 v[126:127], v133 offset:5120
    v_mfma_f32_32x32x16_bf16 v[32:47], v[108:111], v[96:99], v[32:47]
    v_mfma_f32_32x32x16_bf16 v[48:63], v[108:111], v[100:103], v[48:63]
    s_waitcnt lgkmcnt(0)
    v_mfma_f32_32x32x16_bf16 v[0:15], v[120:123], v[112:115], v[0:15]
    ds_read_b128 v[96:99], v130 offset:0
    ds_read_b64_tr_b16 v[104:105], v132 offset:8192
    ds_read_b64_tr_b16 v[106:107], v132 offset:9216
    v_mfma_f32_32x32x16_bf16 v[16:31], v[120:123], v[116:119], v[16:31]
    ds_read_b128 v[100:103], v130 offset:4096
    ds_read_b64_tr_b16 v[108:109], v133 offset:8192
    ds_read_b64_tr_b16 v[110:111], v133 offset:9216
    v_mfma_f32_32x32x16_bf16 v[32:47], v[124:127], v[112:115], v[32:47]
    v_mfma_f32_32x32x16_bf16 v[48:63], v[124:127], v[116:119], v[48:63]
    s_waitcnt lgkmcnt(0)
    v_mfma_f32_32x32x16_bf16 v[0:15], v[104:107], v[96:99], v[0:15]
    ds_read_b128 v[112:115], v131 offset:0
    ds_read_b64_tr_b16 v[120:121], v132 offset:12288
    ds_read_b64_tr_b16 v[122:123], v132 offset:13312
    v_mfma_f32_32x32x16_bf16 v[16:31], v[104:107], v[100:103], v[16:31]
    ds_read_b128 v[116:119], v131 offset:4096
    ds_read_b64_tr_b16 v[124:125], v133 offset:12288
    ds_read_b64_tr_b16 v[126:127], v133 offset:13312
    v_mfma_f32_32x32x16_bf16 v[32:47], v[108:111], v[96:99], v[32:47]
    v_mfma_f32_32x32x16_bf16 v[48:63], v[108:111], v[100:103], v[48:63]
    s_waitcnt lgkmcnt(0)
    s_barrier
    v_mfma_f32_32x32x16_bf16 v[0:15], v[120:123], v[112:115], v[0:15]
    ds_read_b128 v[96:99], v128 offset:32768
    ds_read_b64_tr_b16 v[104:105], v132 offset:32768
    ds_read_b64_tr_b16 v[106:107], v132 offset:33792
    v_mfma_f32_32x32x16_bf16 v[16:31], v[120:123], v[116:119], v[16:31]
    ds_read_b128 v[100:103], v128 offset:36864
    ds_read_b64_tr_b16 v[108:109], v133 offset:32768
    ds_read_b64_tr_b16 v[110:111], v133 offset:33792
    v_mfma_f32_32x32x16_bf16 v[32:47], v[124:127], v[112:115], v[32:47]
    v_mfma_f32_32x32x16_bf16 v[48:63], v[124:127], v[116:119], v[48:63]
    s_waitcnt lgkmcnt(0)
    v_mfma_f32_32x32x16_bf16 v[0:15], v[104:107], v[96:99], v[0:15]
    ds_read_b128 v[112:115], v129 offset:32768
    ds_read_b64_tr_b16 v[120:121], v132 offset:36864
    ds_read_b64_tr_b16 v[122:123], v132 offset:37888
    v_mfma_f32_32x32x16_bf16 v[16:31], v[104:107], v[100:103], v[16:31]
    ds_read_b128 v[116:119], v129 offset:36864
    ds_read_b64_tr_b16 v[124:125], v133 offset:36864
    ds_read_b64_tr_b16 v[126:127], v133 offset:37888
    v_mfma_f32_32x32x16_bf16 v[32:47], v[108:111], v[96:99], v[32:47]
    v_mfma_f32_32x32x16_bf16 v[48:63], v[108:111], v[100:103], v[48:63]
    s_waitcnt lgkmcnt(0)
    v_mfma_f32_32x32x16_bf16 v[0:15], v[120:123], v[112:115], v[0:15]
    ds_read_b128 v[96:99], v130 offset:32768
    ds_read_b64_tr_b16 v[104:105], v132 offset:40960
    ds_read_b64_tr_b16 v[106:107], v132 offset:41984
    v_mfma_f32_32x32x16_bf16 v[16:31], v[120:123], v[116:119], v[16:31]
    ds_read_b128 v[100:103], v130 offset:36864
    ds_read_b64_tr_b16 v[108:109], v133 offset:40960
    ds_read_b64_tr_b16 v[110:111], v133 offset:41984
    v_mfma_f32_32x32x16_bf16 v[32:47], v[124:127], v[112:115], v[32:47]
    v_mfma_f32_32x32x16_bf16 v[48:63], v[124:127], v[116:119], v[48:63]
    s_waitcnt lgkmcnt(0)
    v_mfma_f32_32x32x16_bf16 v[0:15], v[104:107], v[96:99], v[0:15]
    ds_read_b128 v[112:115], v131 offset:32768
    ds_read_b64_tr_b16 v[120:121], v132 offset:45056
    ds_read_b64_tr_b16 v[122:123], v132 offset:46080
    v_mfma_f32_32x32x16_bf16 v[16:31], v[104:107], v[100:103], v[16:31]
    ds_read_b128 v[116:119], v131 offset:36864
    ds_read_b64_tr_b16 v[124:125], v133 offset:45056
    ds_read_b64_tr_b16 v[126:127], v133 offset:46080
    v_mfma_f32_32x32x16_bf16 v[32:47], v[108:111], v[96:99], v[32:47]
    v_mfma_f32_32x32x16_bf16 v[48:63], v[108:111], v[100:103], v[48:63]
    s_waitcnt lgkmcnt(0)
    s_barrier
    v_xor_b32 v128, 0x10000, v128
    v_xor_b32 v129, 0x10000, v129
    v_xor_b32 v130, 0x10000, v130
    v_xor_b32 v131, 0x10000, v131
    v_xor_b32 v132, 0x10000, v132
    v_xor_b32 v133, 0x10000, v133
    v_mfma_f32_32x32x16_bf16 v[0:15], v[120:123], v[112:115], v[0:15]
    ds_read_b128 v[96:99], v128 offset:0
    ds_read_b64_tr_b16 v[104:105], v132 offset:0
    ds_read_b64_tr_b16 v[106:107], v132 offset:1024
    v_mfma_f32_32x32x16_bf16 v[16:31], v[120:123], v[116:119], v[16:31]
    ds_read_b128 v[100:103], v128 offset:4096
    ds_read_b64_tr_b16 v[108:109], v133 offset:0
    ds_read_b64_tr_b16 v[110:111], v133 offset:1024
    v_mfma_f32_32x32x16_bf16 v[32:47], v[124:127], v[112:115], v[32:47]
    v_mfma_f32_32x32x16_bf16 v[48:63], v[124:127], v[116:119], v[48:63]
    s_waitcnt lgkmcnt(0)
    v_mfma_f32_32x32x16_bf16 v[0:15], v[104:107], v[96:99], v[0:15]
    ds_read_b128 v[112:115], v129 offset:0
    ds_read_b64_tr_b16 v[120:121], v132 offset:4096
    ds_read_b64_tr_b16 v[122:123], v132 offset:5120
    v_mfma_f32_32x32x16_bf16 v[16:31], v[104:107], v[100:103], v[16:31]
    ds_read_b128 v[116:119], v129 offset:4096
    ds_read_b64_tr_b16 v[124:125], v133 offset:4096
    ds_read_b64_tr_b16 v[126:127], v133 offset:5120
    v_mfma_f32_32x32x16_bf16 v[32:47], v[108:111], v[96:99], v[32:47]
    v_mfma_f32_32x32x16_bf16 v[48:63], v[108:111], v[100:103], v[48:63]
    s_waitcnt lgkmcnt(0)
    v_mfma_f32_32x32x16_bf16 v[0:15], v[120:123], v[112:115], v[0:15]
    ds_read_b128 v[96:99], v130 offset:0
    ds_read_b64_tr_b16 v[104:105], v132 offset:8192
    ds_read_b64_tr_b16 v[106:107], v132 offset:9216
    v_mfma_f32_32x32x16_bf16 v[16:31], v[120:123], v[116:119], v[16:31]
    ds_read_b128 v[100:103], v130 offset:4096
    ds_read_b64_tr_b16 v[108:109], v133 offset:8192
    ds_read_b64_tr_b16 v[110:111], v133 offset:9216
    v_mfma_f32_32x32x16_bf16 v[32:47], v[124:127], v[112:115], v[32:47]
    ds_read_u16 v144, v136 offset:0
    ds_read_u16 v145, v136 offset:128
    ds_read_u16 v146, v136 offset:256
    v_mfma_f32_32x32x16_bf16 v[48:63], v[124:127], v[116:119], v[48:63]
    ds_read_u16 v147, v136 offset:384
    ds_read_b32 v141, v140 offset:0
    s_waitcnt lgkmcnt(0)
    v_mfma_f32_32x32x16_bf16 v[0:15], v[104:107], v[96:99], v[0:15]
    ds_read_b128 v[112:115], v131 offset:0
    ds_read_b64_tr_b16 v[120:121], v132 offset:12288
    ds_read_b64_tr_b16 v[122:123], v132 offset:13312
    v_mfma_f32_32x32x16_bf16 v[16:31], v[104:107], v[100:103], v[16:31]
    ds_read_b128 v[116:119], v131 offset:4096
    ds_read_b64_tr_b16 v[124:125], v133 offset:12288
    ds_read_b64_tr_b16 v[126:127], v133 offset:13312
    v_mfma_f32_32x32x16_bf16 v[32:47], v[108:111], v[96:99], v[32:47]
    ds_read_u16 v152, v136 offset:4096
    ds_read_u16 v153, v136 offset:4224
    ds_read_u16 v154, v136 offset:4352
    v_mfma_f32_32x32x16_bf16 v[48:63], v[108:111], v[100:103], v[48:63]
    ds_read_u16 v155, v136 offset:4480
    ds_read_b32 v142, v140 offset:128
    s_waitcnt lgkmcnt(0)
    s_barrier
    v_mfma_f32_32x32x16_bf16 v[0:15], v[120:123], v[112:115], v[0:15]
    ds_read_b128 v[96:99], v128 offset:32768
    ds_read_b64_tr_b16 v[104:105], v132 offset:32768
    ds_read_b64_tr_b16 v[106:107], v132 offset:33792
    v_mfma_f32_32x32x16_bf16 v[16:31], v[120:123], v[116:119], v[16:31]
    ds_read_b128 v[100:103], v128 offset:36864
    ds_read_b64_tr_b16 v[108:109], v133 offset:32768
    ds_read_b64_tr_b16 v[110:111], v133 offset:33792
    v_mfma_f32_32x32x16_bf16 v[32:47], v[124:127], v[112:115], v[32:47]
    ds_read_u16 v148, v137 offset:0
    ds_read_u16 v149, v137 offset:128
    ds_read_u16 v150, v137 offset:256
    v_mfma_f32_32x32x16_bf16 v[48:63], v[124:127], v[116:119], v[48:63]
    ds_read_u16 v151, v137 offset:384
    s_waitcnt lgkmcnt(0)
    v_mfma_f32_32x32x16_bf16 v[0:15], v[104:107], v[96:99], v[0:15]
    ds_read_b128 v[112:115], v129 offset:32768
    ds_read_b64_tr_b16 v[120:121], v132 offset:36864
    ds_read_b64_tr_b16 v[122:123], v132 offset:37888
    v_mfma_f32_32x32x16_bf16 v[16:31], v[104:107], v[100:103], v[16:31]
    ds_read_b128 v[116:119], v129 offset:36864
    ds_read_b64_tr_b16 v[124:125], v133 offset:36864
    ds_read_b64_tr_b16 v[126:127], v133 offset:37888
    v_mfma_f32_32x32x16_bf16 v[32:47], v[108:111], v[96:99], v[32:47]
    ds_read_u16 v156, v137 offset:4096
    ds_read_u16 v157, v137 offset:4224
    ds_read_u16 v158, v137 offset:4352
    v_mfma_f32_32x32x16_bf16 v[48:63], v[108:111], v[100:103], v[48:63]
    ds_read_u16 v159, v137 offset:4480
    s_waitcnt lgkmcnt(0)
    v_mfma_f32_32x32x16_bf16 v[0:15], v[120:123], v[112:115], v[0:15]
    ds_read_b128 v[96:99], v130 offset:32768
    ds_read_b64_tr_b16 v[104:105], v132 offset:40960
    ds_read_b64_tr_b16 v[106:107], v132 offset:41984
    v_mfma_f32_32x32x16_bf16 v[16:31], v[120:123], v[116:119], v[16:31]
    ds_read_b128 v[100:103], v130 offset:36864
    ds_read_b64_tr_b16 v[108:109], v133 offset:40960
    ds_read_b64_tr_b16 v[110:111], v133 offset:41984
    v_mfma_f32_32x32x16_bf16 v[32:47], v[124:127], v[112:115], v[32:47]
    v_mfma_f32_32x32x16_bf16 v[48:63], v[124:127], v[116:119], v[48:63]
    s_waitcnt lgkmcnt(0)
    v_lshl_or_b32 v144, v152, 16, v144
    v_lshl_or_b32 v145, v153, 16, v145
    v_lshl_or_b32 v146, v154, 16, v146
    v_lshl_or_b32 v147, v155, 16, v147
    v_lshl_or_b32 v148, v156, 16, v148
    v_lshl_or_b32 v149, v157, 16, v149
    v_lshl_or_b32 v150, v158, 16, v150
    v_lshl_or_b32 v151, v159, 16, v151
    buffer_store_dwordx4 v[144:147], v138, s[68:71], s72 offen sc1
    buffer_store_dwordx4 v[148:151], v138, s[68:71], s73 offen sc1
    v_lshl_or_b32 v141, v142, 16, v141
    s_mov_b64 exec, 0xffffffff
    buffer_store_dword v141, v139, s[68:71], s74 offen sc1
    s_mov_b64 exec, -1
    v_mfma_f32_32x32x16_bf16 v[0:15], v[104:107], v[96:99], v[0:15]
    ds_read_b128 v[112:115], v131 offset:32768
    ds_read_b64_tr_b16 v[120:121], v132 offset:45056
    ds_read_b64_tr_b16 v[122:123], v132 offset:46080
    v_mfma_f32_32x32x16_bf16 v[16:31], v[104:107], v[100:103], v[16:31]
    ds_read_b128 v[116:119], v131 offset:36864
    ds_read_b64_tr_b16 v[124:125], v133 offset:45056
    ds_read_b64_tr_b16 v[126:127], v133 offset:46080
    v_mfma_f32_32x32x16_bf16 v[32:47], v[108:111], v[96:99], v[32:47]
    v_mfma_f32_32x32x16_bf16 v[48:63], v[108:111], v[100:103], v[48:63]
    s_waitcnt lgkmcnt(0)
    s_barrier
    v_xor_b32 v128, 0x10000, v128
    v_xor_b32 v129, 0x10000, v129
    v_xor_b32 v130, 0x10000, v130
    v_xor_b32 v131, 0x10000, v131
    v_xor_b32 v132, 0x10000, v132
    v_xor_b32 v133, 0x10000, v133
    v_mfma_f32_32x32x16_bf16 v[0:15], v[120:123], v[112:115], v[0:15]
    ds_read_b128 v[96:99], v128 offset:0
    ds_read_b64_tr_b16 v[104:105], v132 offset:0
    ds_read_b64_tr_b16 v[106:107], v132 offset:1024
    v_mfma_f32_32x32x16_bf16 v[16:31], v[120:123], v[116:119], v[16:31]
    ds_read_b128 v[100:103], v128 offset:4096
    ds_read_b64_tr_b16 v[108:109], v133 offset:0
    ds_read_b64_tr_b16 v[110:111], v133 offset:1024
    v_mfma_f32_32x32x16_bf16 v[32:47], v[124:127], v[112:115], v[32:47]
    v_mfma_f32_32x32x16_bf16 v[48:63], v[124:127], v[116:119], v[48:63]
    s_waitcnt lgkmcnt(0)
    v_mfma_f32_32x32x16_bf16 v[0:15], v[104:107], v[96:99], v[0:15]
    ds_read_b128 v[112:115], v129 offset:0
    ds_read_b64_tr_b16 v[120:121], v132 offset:4096
    ds_read_b64_tr_b16 v[122:123], v132 offset:5120
    v_mfma_f32_32x32x16_bf16 v[16:31], v[104:107], v[100:103], v[16:31]
    ds_read_b128 v[116:119], v129 offset:4096
    ds_read_b64_tr_b16 v[124:125], v133 offset:4096
    ds_read_b64_tr_b16 v[126:127], v133 offset:5120
    v_mfma_f32_32x32x16_bf16 v[32:47], v[108:111], v[96:99], v[32:47]
    v_mfma_f32_32x32x16_bf16 v[48:63], v[108:111], v[100:103], v[48:63]
    s_waitcnt lgkmcnt(0)
    v_mfma_f32_32x32x16_bf16 v[0:15], v[120:123], v[112:115], v[0:15]
    ds_read_b128 v[96:99], v130 offset:0
    ds_read_b64_tr_b16 v[104:105], v132 offset:8192
    ds_read_b64_tr_b16 v[106:107], v132 offset:9216
    v_mfma_f32_32x32x16_bf16 v[16:31], v[120:123], v[116:119], v[16:31]
    ds_read_b128 v[100:103], v130 offset:4096
    ds_read_b64_tr_b16 v[108:109], v133 offset:8192
    ds_read_b64_tr_b16 v[110:111], v133 offset:9216
    v_mfma_f32_32x32x16_bf16 v[32:47], v[124:127], v[112:115], v[32:47]
    v_mfma_f32_32x32x16_bf16 v[48:63], v[124:127], v[116:119], v[48:63]
    s_waitcnt lgkmcnt(0)
    v_mfma_f32_32x32x16_bf16 v[0:15], v[104:107], v[96:99], v[0:15]
    ds_read_b128 v[112:115], v131 offset:0
    ds_read_b64_tr_b16 v[120:121], v132 offset:12288
    ds_read_b64_tr_b16 v[122:123], v132 offset:13312
    v_mfma_f32_32x32x16_bf16 v[16:31], v[104:107], v[100:103], v[16:31]
    ds_read_b128 v[116:119], v131 offset:4096
    ds_read_b64_tr_b16 v[124:125], v133 offset:12288
    ds_read_b64_tr_b16 v[126:127], v133 offset:13312
    v_mfma_f32_32x32x16_bf16 v[32:47], v[108:111], v[96:99], v[32:47]
    v_mfma_f32_32x32x16_bf16 v[48:63], v[108:111], v[100:103], v[48:63]
    s_waitcnt lgkmcnt(0)
    s_barrier
    v_mfma_f32_32x32x16_bf16 v[0:15], v[120:123], v[112:115], v[0:15]
    ds_read_b128 v[96:99], v128 offset:32768
    ds_read_b64_tr_b16 v[104:105], v132 offset:32768
    ds_read_b64_tr_b16 v[106:107], v132 offset:33792
    v_mfma_f32_32x32x16_bf16 v[16:31], v[120:123], v[116:119], v[16:31]
    ds_read_b128 v[100:103], v128 offset:36864
    ds_read_b64_tr_b16 v[108:109], v133 offset:32768
    ds_read_b64_tr_b16 v[110:111], v133 offset:33792
    v_mfma_f32_32x32x16_bf16 v[32:47], v[124:127], v[112:115], v[32:47]
    v_mfma_f32_32x32x16_bf16 v[48:63], v[124:127], v[116:119], v[48:63]
    s_waitcnt lgkmcnt(0)
    v_mfma_f32_32x32x16_bf16 v[0:15], v[104:107], v[96:99], v[0:15]
    ds_read_b128 v[112:115], v129 offset:32768
    ds_read_b64_tr_b16 v[120:121], v132 offset:36864
    ds_read_b64_tr_b16 v[122:123], v132 offset:37888
    v_mfma_f32_32x32x16_bf16 v[16:31], v[104:107], v[100:103], v[16:31]
    ds_read_b128 v[116:119], v129 offset:36864
    ds_read_b64_tr_b16 v[124:125], v133 offset:36864
    ds_read_b64_tr_b16 v[126:127], v133 offset:37888
    v_mfma_f32_32x32x16_bf16 v[32:47], v[108:111], v[96:99], v[32:47]
    v_lshlrev_b32 v142, 4, v170
    s_mov_b32 s16, 0xbdd2d3e8
    v_mfma_f32_32x32x16_bf16 v[48:63], v[108:111], v[100:103], v[48:63]
    s_mov_b32 s17, s16
    v_mov_b32 v134, 0xc0135761
    s_waitcnt lgkmcnt(0)
    v_mfma_f32_32x32x16_bf16 v[0:15], v[120:123], v[112:115], v[0:15]
    ds_read_b128 v[96:99], v130 offset:32768
    ds_read_b64_tr_b16 v[104:105], v132 offset:40960
    ds_read_b64_tr_b16 v[106:107], v132 offset:41984
    v_mfma_f32_32x32x16_bf16 v[16:31], v[120:123], v[116:119], v[16:31]
    ds_read_b128 v[100:103], v130 offset:36864
    ds_read_b64_tr_b16 v[108:109], v133 offset:40960
    ds_read_b64_tr_b16 v[110:111], v133 offset:41984
    v_mfma_f32_32x32x16_bf16 v[32:47], v[124:127], v[112:115], v[32:47]
    v_mov_b32 v135, 0xc0135761
    v_mov_b32 v165, 139264
    v_mfma_f32_32x32x16_bf16 v[48:63], v[124:127], v[116:119], v[48:63]
    v_mov_b32 v166, 1
    s_lshl_b32 s13, s8, 1
    s_waitcnt lgkmcnt(0)
    v_mfma_f32_32x32x16_bf16 v[0:15], v[104:107], v[96:99], v[0:15]
    ds_read_b128 v[112:115], v131 offset:32768
    ds_read_b64_tr_b16 v[120:121], v132 offset:45056
    ds_read_b64_tr_b16 v[122:123], v132 offset:46080
    v_mfma_f32_32x32x16_bf16 v[16:31], v[104:107], v[100:103], v[16:31]
    ds_read_b128 v[116:119], v131 offset:36864
    ds_read_b64_tr_b16 v[124:125], v133 offset:45056
    ds_read_b64_tr_b16 v[126:127], v133 offset:46080
    v_mfma_f32_32x32x16_bf16 v[32:47], v[108:111], v[96:99], v[32:47]
    s_add_u32 s13, s13, s22
    s_mul_i32 s14, s13, 230400
    v_mfma_f32_32x32x16_bf16 v[48:63], v[108:111], v[100:103], v[48:63]
    s_lshl_b32 s15, s25, 1
    s_add_u32 s15, s15, s23
    s_waitcnt lgkmcnt(0)
    s_barrier
    v_xor_b32 v128, 0x10000, v128
    v_xor_b32 v129, 0x10000, v129
    v_xor_b32 v130, 0x10000, v130
    v_xor_b32 v131, 0x10000, v131
    v_xor_b32 v132, 0x10000, v132
    v_xor_b32 v133, 0x10000, v133
    v_mfma_f32_32x32x16_bf16 v[0:15], v[120:123], v[112:115], v[0:15]
    ds_read_b128 v[96:99], v128 offset:0
    ds_read_b64_tr_b16 v[104:105], v132 offset:0
    ds_read_b64_tr_b16 v[106:107], v132 offset:1024
    v_mfma_f32_32x32x16_bf16 v[16:31], v[120:123], v[116:119], v[16:31]
    ds_read_b128 v[100:103], v128 offset:4096
    ds_read_b64_tr_b16 v[108:109], v133 offset:0
    ds_read_b64_tr_b16 v[110:111], v133 offset:1024
    v_mfma_f32_32x32x16_bf16 v[32:47], v[124:127], v[112:115], v[32:47]
    s_lshl_b32 s19, s15, 13
    s_add_u32 s14, s14, s19
    v_mfma_f32_32x32x16_bf16 v[48:63], v[124:127], v[116:119], v[48:63]
    s_add_u32 s14, s14, 9437184
    s_add_u32 s18, s14, 4096
    s_waitcnt lgkmcnt(0)
    v_mfma_f32_32x32x16_bf16 v[0:15], v[104:107], v[96:99], v[0:15]
    ds_read_b128 v[112:115], v129 offset:0
    ds_read_b64_tr_b16 v[120:121], v132 offset:4096
    ds_read_b64_tr_b16 v[122:123], v132 offset:5120
    v_mfma_f32_32x32x16_bf16 v[16:31], v[104:107], v[100:103], v[16:31]
    ds_read_b128 v[116:119], v129 offset:4096
    ds_read_b64_tr_b16 v[124:125], v133 offset:4096
    ds_read_b64_tr_b16 v[126:127], v133 offset:5120
    v_mfma_f32_32x32x16_bf16 v[32:47], v[108:111], v[96:99], v[32:47]
    s_lshl_b32 s13, s10, 2
    s_add_u32 s13, s13, s5
    v_mfma_f32_32x32x16_bf16 v[48:63], v[108:111], v[100:103], v[48:63]
    s_add_u32 s13, s13, 192
    s_waitcnt lgkmcnt(0)
    v_mfma_f32_32x32x16_bf16 v[0:15], v[120:123], v[112:115], v[0:15]
    ds_read_b128 v[96:99], v130 offset:0
    ds_read_b64_tr_b16 v[104:105], v132 offset:8192
    ds_read_b64_tr_b16 v[106:107], v132 offset:9216
    v_mfma_f32_32x32x16_bf16 v[16:31], v[120:123], v[116:119], v[16:31]
    ds_read_b128 v[100:103], v130 offset:4096
    ds_read_b64_tr_b16 v[108:109], v133 offset:8192
    ds_read_b64_tr_b16 v[110:111], v133 offset:9216
    v_mfma_f32_32x32x16_bf16 v[32:47], v[124:127], v[112:115], v[32:47]
    v_mfma_f32_32x32x16_bf16 v[48:63], v[124:127], v[116:119], v[48:63]
    s_waitcnt lgkmcnt(0)
    v_mfma_f32_32x32x16_bf16 v[0:15], v[104:107], v[96:99], v[0:15]
    ds_read_b128 v[112:115], v131 offset:0
    ds_read_b64_tr_b16 v[120:121], v132 offset:12288
    ds_read_b64_tr_b16 v[122:123], v132 offset:13312
    v_mfma_f32_32x32x16_bf16 v[16:31], v[104:107], v[100:103], v[16:31]
    ds_read_b128 v[116:119], v131 offset:4096
    ds_read_b64_tr_b16 v[124:125], v133 offset:12288
    ds_read_b64_tr_b16 v[126:127], v133 offset:13312
    v_mfma_f32_32x32x16_bf16 v[32:47], v[108:111], v[96:99], v[32:47]
    v_mfma_f32_32x32x16_bf16 v[48:63], v[108:111], v[100:103], v[48:63]
    s_waitcnt lgkmcnt(0)
    s_waitcnt vmcnt(0)
    s_barrier
    v_mfma_f32_32x32x16_bf16 v[0:15], v[120:123], v[112:115], v[0:15]
    ds_read_b128 v[96:99], v128 offset:32768
    ds_read_b64_tr_b16 v[104:105], v132 offset:32768
    ds_read_b64_tr_b16 v[106:107], v132 offset:33792
    v_mfma_f32_32x32x16_bf16 v[16:31], v[120:123], v[116:119], v[16:31]
    ds_read_b128 v[100:103], v128 offset:36864
    ds_read_b64_tr_b16 v[108:109], v133 offset:32768
    ds_read_b64_tr_b16 v[110:111], v133 offset:33792
    v_mfma_f32_32x32x16_bf16 v[32:47], v[124:127], v[112:115], v[32:47]
    v_mfma_f32_32x32x16_bf16 v[48:63], v[124:127], v[116:119], v[48:63]
    s_waitcnt lgkmcnt(0)
    v_mfma_f32_32x32x16_bf16 v[0:15], v[104:107], v[96:99], v[0:15]
    ds_read_b128 v[112:115], v129 offset:32768
    ds_read_b64_tr_b16 v[120:121], v132 offset:36864
    ds_read_b64_tr_b16 v[122:123], v132 offset:37888
    v_mfma_f32_32x32x16_bf16 v[16:31], v[104:107], v[100:103], v[16:31]
    ds_read_b128 v[116:119], v129 offset:36864
    ds_read_b64_tr_b16 v[124:125], v133 offset:36864
    ds_read_b64_tr_b16 v[126:127], v133 offset:37888
    v_mfma_f32_32x32x16_bf16 v[32:47], v[108:111], v[96:99], v[32:47]
    v_mfma_f32_32x32x16_bf16 v[48:63], v[108:111], v[100:103], v[48:63]
    s_waitcnt lgkmcnt(0)
    v_mfma_f32_32x32x16_bf16 v[0:15], v[120:123], v[112:115], v[0:15]
    ds_read_b128 v[96:99], v130 offset:32768
    ds_read_b64_tr_b16 v[104:105], v132 offset:40960
    ds_read_b64_tr_b16 v[106:107], v132 offset:41984
    v_mfma_f32_32x32x16_bf16 v[16:31], v[120:123], v[116:119], v[16:31]
    ds_read_b128 v[100:103], v130 offset:36864
    ds_read_b64_tr_b16 v[108:109], v133 offset:40960
    ds_read_b64_tr_b16 v[110:111], v133 offset:41984
    v_mfma_f32_32x32x16_bf16 v[32:47], v[124:127], v[112:115], v[32:47]
    v_mfma_f32_32x32x16_bf16 v[48:63], v[124:127], v[116:119], v[48:63]
    s_waitcnt lgkmcnt(0)
    v_mfma_f32_32x32x16_bf16 v[0:15], v[104:107], v[96:99], v[0:15]
    ds_read_b128 v[112:115], v131 offset:32768
    ds_read_b64_tr_b16 v[120:121], v132 offset:45056
    ds_read_b64_tr_b16 v[122:123], v132 offset:46080
    v_mfma_f32_32x32x16_bf16 v[16:31], v[104:107], v[100:103], v[16:31]
    ds_read_b128 v[116:119], v131 offset:36864
    ds_read_b64_tr_b16 v[124:125], v133 offset:45056
    ds_read_b64_tr_b16 v[126:127], v133 offset:46080
    v_mfma_f32_32x32x16_bf16 v[32:47], v[108:111], v[96:99], v[32:47]
    v_mfma_f32_32x32x16_bf16 v[48:63], v[108:111], v[100:103], v[48:63]
    s_waitcnt lgkmcnt(0)
    v_mfma_f32_32x32x16_bf16 v[0:15], v[120:123], v[112:115], v[0:15]
    v_mfma_f32_32x32x16_bf16 v[16:31], v[120:123], v[116:119], v[16:31]
    v_mfma_f32_32x32x16_bf16 v[32:47], v[124:127], v[112:115], v[32:47]
    v_mfma_f32_32x32x16_bf16 v[48:63], v[124:127], v[116:119], v[48:63]
    s_nop 8
    v_pk_mul_f32 v[144:145], v[0:1], v[0:1]
    v_pk_mul_f32 v[146:147], v[2:3], v[2:3]
    v_pk_mul_f32 v[148:149], v[4:5], v[4:5]
    v_pk_mul_f32 v[150:151], v[6:7], v[6:7]
    v_pk_mul_f32 v[152:153], v[8:9], v[8:9]
    v_pk_mul_f32 v[154:155], v[10:11], v[10:11]
    v_pk_mul_f32 v[156:157], v[12:13], v[12:13]
    v_pk_mul_f32 v[158:159], v[14:15], v[14:15]
    v_pk_fma_f32 v[144:145], v[144:145], s[16:17], v[134:135]
    v_pk_fma_f32 v[146:147], v[146:147], s[16:17], v[134:135]
    v_pk_fma_f32 v[148:149], v[148:149], s[16:17], v[134:135]
    v_pk_fma_f32 v[150:151], v[150:151], s[16:17], v[134:135]
    v_pk_fma_f32 v[152:153], v[152:153], s[16:17], v[134:135]
    v_pk_fma_f32 v[154:155], v[154:155], s[16:17], v[134:135]
    v_pk_fma_f32 v[156:157], v[156:157], s[16:17], v[134:135]
    v_pk_fma_f32 v[158:159], v[158:159], s[16:17], v[134:135]
    v_pk_mul_f32 v[144:145], v[144:145], v[0:1]
    v_pk_mul_f32 v[146:147], v[146:147], v[2:3]
    v_pk_mul_f32 v[148:149], v[148:149], v[4:5]
    v_pk_mul_f32 v[150:151], v[150:151], v[6:7]
    v_pk_mul_f32 v[152:153], v[152:153], v[8:9]
    v_pk_mul_f32 v[154:155], v[154:155], v[10:11]
    v_pk_mul_f32 v[156:157], v[156:157], v[12:13]
    v_pk_mul_f32 v[158:159], v[158:159], v[14:15]
    v_exp_f32 v144, v144
    v_exp_f32 v145, v145
    v_exp_f32 v146, v146
    v_exp_f32 v147, v147
    v_exp_f32 v148, v148
    v_exp_f32 v149, v149
    v_exp_f32 v150, v150
    v_exp_f32 v151, v151
    v_exp_f32 v152, v152
    v_exp_f32 v153, v153
    v_exp_f32 v154, v154
    v_exp_f32 v155, v155
    v_exp_f32 v156, v156
    v_exp_f32 v157, v157
    v_exp_f32 v158, v158
    v_exp_f32 v159, v159
    v_pk_add_f32 v[144:145], v[144:145], 1.0 op_sel_hi:[1,0]
    v_pk_add_f32 v[146:147], v[146:147], 1.0 op_sel_hi:[1,0]
    v_pk_add_f32 v[148:149], v[148:149], 1.0 op_sel_hi:[1,0]
    v_pk_add_f32 v[150:151], v[150:151], 1.0 op_sel_hi:[1,0]
    v_pk_add_f32 v[152:153], v[152:153], 1.0 op_sel_hi:[1,0]
    v_pk_add_f32 v[154:155], v[154:155], 1.0 op_sel_hi:[1,0]
    v_pk_add_f32 v[156:157], v[156:157], 1.0 op_sel_hi:[1,0]
    v_pk_add_f32 v[158:159], v[158:159], 1.0 op_sel_hi:[1,0]
    v_rcp_f32 v144, v144
    v_rcp_f32 v145, v145
    v_rcp_f32 v146, v146
    v_rcp_f32 v147, v147
    v_rcp_f32 v148, v148
    v_rcp_f32 v149, v149
    v_rcp_f32 v150, v150
    v_rcp_f32 v151, v151
    v_rcp_f32 v152, v152
    v_rcp_f32 v153, v153
    v_rcp_f32 v154, v154
    v_rcp_f32 v155, v155
    v_rcp_f32 v156, v156
    v_rcp_f32 v157, v157
    v_rcp_f32 v158, v158
    v_rcp_f32 v159, v159
    v_pk_mul_f32 v[144:145], v[144:145], v[0:1]
    v_pk_mul_f32 v[146:147], v[146:147], v[2:3]
    v_pk_mul_f32 v[148:149], v[148:149], v[4:5]
    v_pk_mul_f32 v[150:151], v[150:151], v[6:7]
    v_pk_mul_f32 v[152:153], v[152:153], v[8:9]
    v_pk_mul_f32 v[154:155], v[154:155], v[10:11]
    v_pk_mul_f32 v[156:157], v[156:157], v[12:13]
    v_pk_mul_f32 v[158:159], v[158:159], v[14:15]
    v_cvt_pk_bf16_f32 v64, v144, v145
    v_cvt_pk_bf16_f32 v65, v146, v147
    v_cvt_pk_bf16_f32 v66, v148, v149
    v_cvt_pk_bf16_f32 v67, v150, v151
    v_cvt_pk_bf16_f32 v68, v152, v153
    v_cvt_pk_bf16_f32 v69, v154, v155
    v_cvt_pk_bf16_f32 v70, v156, v157
    v_cvt_pk_bf16_f32 v71, v158, v159
    buffer_store_dwordx4 v[64:67], v142, s[68:71], s14 offen offset:0 sc1
    buffer_store_dwordx4 v[68:71], v142, s[68:71], s14 offen offset:2048 sc1
    v_pk_mul_f32 v[144:145], v[16:17], v[16:17]
    v_pk_mul_f32 v[146:147], v[18:19], v[18:19]
    v_pk_mul_f32 v[148:149], v[20:21], v[20:21]
    v_pk_mul_f32 v[150:151], v[22:23], v[22:23]
    v_pk_mul_f32 v[152:153], v[24:25], v[24:25]
    v_pk_mul_f32 v[154:155], v[26:27], v[26:27]
    v_pk_mul_f32 v[156:157], v[28:29], v[28:29]
    v_pk_mul_f32 v[158:159], v[30:31], v[30:31]
    v_pk_fma_f32 v[144:145], v[144:145], s[16:17], v[134:135]
    v_pk_fma_f32 v[146:147], v[146:147], s[16:17], v[134:135]
    v_pk_fma_f32 v[148:149], v[148:149], s[16:17], v[134:135]
    v_pk_fma_f32 v[150:151], v[150:151], s[16:17], v[134:135]
    v_pk_fma_f32 v[152:153], v[152:153], s[16:17], v[134:135]
    v_pk_fma_f32 v[154:155], v[154:155], s[16:17], v[134:135]
    v_pk_fma_f32 v[156:157], v[156:157], s[16:17], v[134:135]
    v_pk_fma_f32 v[158:159], v[158:159], s[16:17], v[134:135]
    v_pk_mul_f32 v[144:145], v[144:145], v[16:17]
    v_pk_mul_f32 v[146:147], v[146:147], v[18:19]
    v_pk_mul_f32 v[148:149], v[148:149], v[20:21]
    v_pk_mul_f32 v[150:151], v[150:151], v[22:23]
    v_pk_mul_f32 v[152:153], v[152:153], v[24:25]
    v_pk_mul_f32 v[154:155], v[154:155], v[26:27]
    v_pk_mul_f32 v[156:157], v[156:157], v[28:29]
    v_pk_mul_f32 v[158:159], v[158:159], v[30:31]
    v_exp_f32 v144, v144
    v_exp_f32 v145, v145
    v_exp_f32 v146, v146
    v_exp_f32 v147, v147
    v_exp_f32 v148, v148
    v_exp_f32 v149, v149
    v_exp_f32 v150, v150
    v_exp_f32 v151, v151
    v_exp_f32 v152, v152
    v_exp_f32 v153, v153
    v_exp_f32 v154, v154
    v_exp_f32 v155, v155
    v_exp_f32 v156, v156
    v_exp_f32 v157, v157
    v_exp_f32 v158, v158
    v_exp_f32 v159, v159
    v_pk_add_f32 v[144:145], v[144:145], 1.0 op_sel_hi:[1,0]
    v_pk_add_f32 v[146:147], v[146:147], 1.0 op_sel_hi:[1,0]
    v_pk_add_f32 v[148:149], v[148:149], 1.0 op_sel_hi:[1,0]
    v_pk_add_f32 v[150:151], v[150:151], 1.0 op_sel_hi:[1,0]
    v_pk_add_f32 v[152:153], v[152:153], 1.0 op_sel_hi:[1,0]
    v_pk_add_f32 v[154:155], v[154:155], 1.0 op_sel_hi:[1,0]
    v_pk_add_f32 v[156:157], v[156:157], 1.0 op_sel_hi:[1,0]
    v_pk_add_f32 v[158:159], v[158:159], 1.0 op_sel_hi:[1,0]
    v_rcp_f32 v144, v144
    v_rcp_f32 v145, v145
    v_rcp_f32 v146, v146
    v_rcp_f32 v147, v147
    v_rcp_f32 v148, v148
    v_rcp_f32 v149, v149
    v_rcp_f32 v150, v150
    v_rcp_f32 v151, v151
    v_rcp_f32 v152, v152
    v_rcp_f32 v153, v153
    v_rcp_f32 v154, v154
    v_rcp_f32 v155, v155
    v_rcp_f32 v156, v156
    v_rcp_f32 v157, v157
    v_rcp_f32 v158, v158
    v_rcp_f32 v159, v159
    v_pk_mul_f32 v[144:145], v[144:145], v[16:17]
    v_pk_mul_f32 v[146:147], v[146:147], v[18:19]
    v_pk_mul_f32 v[148:149], v[148:149], v[20:21]
    v_pk_mul_f32 v[150:151], v[150:151], v[22:23]
    v_pk_mul_f32 v[152:153], v[152:153], v[24:25]
    v_pk_mul_f32 v[154:155], v[154:155], v[26:27]
    v_pk_mul_f32 v[156:157], v[156:157], v[28:29]
    v_pk_mul_f32 v[158:159], v[158:159], v[30:31]
    v_cvt_pk_bf16_f32 v72, v144, v145
    v_cvt_pk_bf16_f32 v73, v146, v147
    v_cvt_pk_bf16_f32 v74, v148, v149
    v_cvt_pk_bf16_f32 v75, v150, v151
    v_cvt_pk_bf16_f32 v76, v152, v153
    v_cvt_pk_bf16_f32 v77, v154, v155
    v_cvt_pk_bf16_f32 v78, v156, v157
    v_cvt_pk_bf16_f32 v79, v158, v159
    buffer_store_dwordx4 v[72:75], v142, s[68:71], s14 offen offset:1024 sc1
    buffer_store_dwordx4 v[76:79], v142, s[68:71], s14 offen offset:3072 sc1
    v_pk_mul_f32 v[144:145], v[32:33], v[32:33]
    v_pk_mul_f32 v[146:147], v[34:35], v[34:35]
    v_pk_mul_f32 v[148:149], v[36:37], v[36:37]
    v_pk_mul_f32 v[150:151], v[38:39], v[38:39]
    v_pk_mul_f32 v[152:153], v[40:41], v[40:41]
    v_pk_mul_f32 v[154:155], v[42:43], v[42:43]
    v_pk_mul_f32 v[156:157], v[44:45], v[44:45]
    v_pk_mul_f32 v[158:159], v[46:47], v[46:47]
    v_pk_fma_f32 v[144:145], v[144:145], s[16:17], v[134:135]
    v_pk_fma_f32 v[146:147], v[146:147], s[16:17], v[134:135]
    v_pk_fma_f32 v[148:149], v[148:149], s[16:17], v[134:135]
    v_pk_fma_f32 v[150:151], v[150:151], s[16:17], v[134:135]
    v_pk_fma_f32 v[152:153], v[152:153], s[16:17], v[134:135]
    v_pk_fma_f32 v[154:155], v[154:155], s[16:17], v[134:135]
    v_pk_fma_f32 v[156:157], v[156:157], s[16:17], v[134:135]
    v_pk_fma_f32 v[158:159], v[158:159], s[16:17], v[134:135]
    v_pk_mul_f32 v[144:145], v[144:145], v[32:33]
    v_pk_mul_f32 v[146:147], v[146:147], v[34:35]
    v_pk_mul_f32 v[148:149], v[148:149], v[36:37]
    v_pk_mul_f32 v[150:151], v[150:151], v[38:39]
    v_pk_mul_f32 v[152:153], v[152:153], v[40:41]
    v_pk_mul_f32 v[154:155], v[154:155], v[42:43]
    v_pk_mul_f32 v[156:157], v[156:157], v[44:45]
    v_pk_mul_f32 v[158:159], v[158:159], v[46:47]
    v_exp_f32 v144, v144
    v_exp_f32 v145, v145
    v_exp_f32 v146, v146
    v_exp_f32 v147, v147
    v_exp_f32 v148, v148
    v_exp_f32 v149, v149
    v_exp_f32 v150, v150
    v_exp_f32 v151, v151
    v_exp_f32 v152, v152
    v_exp_f32 v153, v153
    v_exp_f32 v154, v154
    v_exp_f32 v155, v155
    v_exp_f32 v156, v156
    v_exp_f32 v157, v157
    v_exp_f32 v158, v158
    v_exp_f32 v159, v159
    v_pk_add_f32 v[144:145], v[144:145], 1.0 op_sel_hi:[1,0]
    v_pk_add_f32 v[146:147], v[146:147], 1.0 op_sel_hi:[1,0]
    v_pk_add_f32 v[148:149], v[148:149], 1.0 op_sel_hi:[1,0]
    v_pk_add_f32 v[150:151], v[150:151], 1.0 op_sel_hi:[1,0]
    v_pk_add_f32 v[152:153], v[152:153], 1.0 op_sel_hi:[1,0]
    v_pk_add_f32 v[154:155], v[154:155], 1.0 op_sel_hi:[1,0]
    v_pk_add_f32 v[156:157], v[156:157], 1.0 op_sel_hi:[1,0]
    v_pk_add_f32 v[158:159], v[158:159], 1.0 op_sel_hi:[1,0]
    v_rcp_f32 v144, v144
    v_rcp_f32 v145, v145
    v_rcp_f32 v146, v146
    v_rcp_f32 v147, v147
    v_rcp_f32 v148, v148
    v_rcp_f32 v149, v149
    v_rcp_f32 v150, v150
    v_rcp_f32 v151, v151
    v_rcp_f32 v152, v152
    v_rcp_f32 v153, v153
    v_rcp_f32 v154, v154
    v_rcp_f32 v155, v155
    v_rcp_f32 v156, v156
    v_rcp_f32 v157, v157
    v_rcp_f32 v158, v158
    v_rcp_f32 v159, v159
    v_pk_mul_f32 v[144:145], v[144:145], v[32:33]
    v_pk_mul_f32 v[146:147], v[146:147], v[34:35]
    v_pk_mul_f32 v[148:149], v[148:149], v[36:37]
    v_pk_mul_f32 v[150:151], v[150:151], v[38:39]
    v_pk_mul_f32 v[152:153], v[152:153], v[40:41]
    v_pk_mul_f32 v[154:155], v[154:155], v[42:43]
    v_pk_mul_f32 v[156:157], v[156:157], v[44:45]
    v_pk_mul_f32 v[158:159], v[158:159], v[46:47]
    v_cvt_pk_bf16_f32 v80, v144, v145
    v_cvt_pk_bf16_f32 v81, v146, v147
    v_cvt_pk_bf16_f32 v82, v148, v149
    v_cvt_pk_bf16_f32 v83, v150, v151
    v_cvt_pk_bf16_f32 v84, v152, v153
    v_cvt_pk_bf16_f32 v85, v154, v155
    v_cvt_pk_bf16_f32 v86, v156, v157
    v_cvt_pk_bf16_f32 v87, v158, v159
    buffer_store_dwordx4 v[80:83], v142, s[68:71], s18 offen offset:0 sc1
    buffer_store_dwordx4 v[84:87], v142, s[68:71], s18 offen offset:2048 sc1
    v_pk_mul_f32 v[144:145], v[48:49], v[48:49]
    v_pk_mul_f32 v[146:147], v[50:51], v[50:51]
    v_pk_mul_f32 v[148:149], v[52:53], v[52:53]
    v_pk_mul_f32 v[150:151], v[54:55], v[54:55]
    v_pk_mul_f32 v[152:153], v[56:57], v[56:57]
    v_pk_mul_f32 v[154:155], v[58:59], v[58:59]
    v_pk_mul_f32 v[156:157], v[60:61], v[60:61]
    v_pk_mul_f32 v[158:159], v[62:63], v[62:63]
    v_pk_fma_f32 v[144:145], v[144:145], s[16:17], v[134:135]
    v_pk_fma_f32 v[146:147], v[146:147], s[16:17], v[134:135]
    v_pk_fma_f32 v[148:149], v[148:149], s[16:17], v[134:135]
    v_pk_fma_f32 v[150:151], v[150:151], s[16:17], v[134:135]
    v_pk_fma_f32 v[152:153], v[152:153], s[16:17], v[134:135]
    v_pk_fma_f32 v[154:155], v[154:155], s[16:17], v[134:135]
    v_pk_fma_f32 v[156:157], v[156:157], s[16:17], v[134:135]
    v_pk_fma_f32 v[158:159], v[158:159], s[16:17], v[134:135]
    v_pk_mul_f32 v[144:145], v[144:145], v[48:49]
    v_pk_mul_f32 v[146:147], v[146:147], v[50:51]
    v_pk_mul_f32 v[148:149], v[148:149], v[52:53]
    v_pk_mul_f32 v[150:151], v[150:151], v[54:55]
    v_pk_mul_f32 v[152:153], v[152:153], v[56:57]
    v_pk_mul_f32 v[154:155], v[154:155], v[58:59]
    v_pk_mul_f32 v[156:157], v[156:157], v[60:61]
    v_pk_mul_f32 v[158:159], v[158:159], v[62:63]
    v_exp_f32 v144, v144
    v_exp_f32 v145, v145
    v_exp_f32 v146, v146
    v_exp_f32 v147, v147
    v_exp_f32 v148, v148
    v_exp_f32 v149, v149
    v_exp_f32 v150, v150
    v_exp_f32 v151, v151
    v_exp_f32 v152, v152
    v_exp_f32 v153, v153
    v_exp_f32 v154, v154
    v_exp_f32 v155, v155
    v_exp_f32 v156, v156
    v_exp_f32 v157, v157
    v_exp_f32 v158, v158
    v_exp_f32 v159, v159
    v_pk_add_f32 v[144:145], v[144:145], 1.0 op_sel_hi:[1,0]
    v_pk_add_f32 v[146:147], v[146:147], 1.0 op_sel_hi:[1,0]
    v_pk_add_f32 v[148:149], v[148:149], 1.0 op_sel_hi:[1,0]
    v_pk_add_f32 v[150:151], v[150:151], 1.0 op_sel_hi:[1,0]
    v_pk_add_f32 v[152:153], v[152:153], 1.0 op_sel_hi:[1,0]
    v_pk_add_f32 v[154:155], v[154:155], 1.0 op_sel_hi:[1,0]
    v_pk_add_f32 v[156:157], v[156:157], 1.0 op_sel_hi:[1,0]
    v_pk_add_f32 v[158:159], v[158:159], 1.0 op_sel_hi:[1,0]
    v_rcp_f32 v144, v144
    v_rcp_f32 v145, v145
    v_rcp_f32 v146, v146
    v_rcp_f32 v147, v147
    v_rcp_f32 v148, v148
    v_rcp_f32 v149, v149
    v_rcp_f32 v150, v150
    v_rcp_f32 v151, v151
    v_rcp_f32 v152, v152
    v_rcp_f32 v153, v153
    v_rcp_f32 v154, v154
    v_rcp_f32 v155, v155
    v_rcp_f32 v156, v156
    v_rcp_f32 v157, v157
    v_rcp_f32 v158, v158
    v_rcp_f32 v159, v159
    v_pk_mul_f32 v[144:145], v[144:145], v[48:49]
    v_pk_mul_f32 v[146:147], v[146:147], v[50:51]
    v_pk_mul_f32 v[148:149], v[148:149], v[52:53]
    v_pk_mul_f32 v[150:151], v[150:151], v[54:55]
    v_pk_mul_f32 v[152:153], v[152:153], v[56:57]
    v_pk_mul_f32 v[154:155], v[154:155], v[58:59]
    v_pk_mul_f32 v[156:157], v[156:157], v[60:61]
    v_pk_mul_f32 v[158:159], v[158:159], v[62:63]
    v_cvt_pk_bf16_f32 v88, v144, v145
    v_cvt_pk_bf16_f32 v89, v146, v147
    v_cvt_pk_bf16_f32 v90, v148, v149
    v_cvt_pk_bf16_f32 v91, v150, v151
    v_cvt_pk_bf16_f32 v92, v152, v153
    v_cvt_pk_bf16_f32 v93, v154, v155
    v_cvt_pk_bf16_f32 v94, v156, v157
    v_cvt_pk_bf16_f32 v95, v158, v159
    buffer_store_dwordx4 v[88:91], v142, s[68:71], s18 offen offset:1024 sc1
    buffer_store_dwordx4 v[92:95], v142, s[68:71], s18 offen offset:3072 sc1
    s_mov_b64 exec, 1
    ds_add_u32 v165, v166 offset:32
    s_mov_b64 exec, -1
    s_mov_b32 s81, s13
    s_branch L_cons_common
L_cons2:
    s_and_b32 s5, s4, 3
    s_lshr_b32 s7, s2, 3
    s_and_b32 s8, s2, 6
    s_lshl_b32 s8, s8, 1
    s_lshr_b32 s81, s2, 6
    s_add_u32 s8, s8, s81
    s_mov_b32 s30, 2097152
    s_mov_b32 s31, 0x20000
    s_load_dwordx2 s[32:33], s[0:1], 8
    s_load_dwordx2 s[36:37], s[0:1], 16
    s_load_dwordx2 s[44:45], s[0:1], 40
    s_load_dwordx2 s[48:49], s[0:1], 48
    s_load_dwordx2 s[52:53], s[0:1], 56
    s_load_dwordx2 s[56:57], s[0:1], 64
    s_load_dwordx2 s[60:61], s[0:1], 72
    s_load_dwordx2 s[64:65], s[0:1], 80
    s_and_b32 s6, s2, 7
    s_and_b32 s3, s2, 1
    s_mul_i32 s25, s3, 7
    s_add_u32 s25, s25, s11
    s_add_u32 s9, s25, s3
    s_lshl_b32 s10, s8, 1
    s_add_u32 s10, s10, s3
    s_and_b32 s13, s7, 1
    s_lshl_b32 s13, s13, 1
    s_or_b32 s12, s3, s13
    s_and_b32 s13, s2, 6
    s_lshl_b32 s13, s13, 1
    s_or_b32 s12, s12, s13
    s_and_b32 s13, s7, 14
    s_lshl_b32 s13, s13, 3
    s_or_b32 s12, s12, s13
    s_sub_u32 s13, 256, s12
    s_cmp_eq_u32 s12, 0
    s_cselect_b32 s13, 128, s13
    s_cmp_ge_u32 s7, 16
    s_cselect_b32 s12, s13, s12
    s_mov_b32 s70, 23068672
    s_mov_b32 s71, 0x20000
    s_mov_b32 s34, 1052672
    s_mov_b32 s35, 0x20000
    s_mov_b32 s38, 1052672
    s_mov_b32 s39, 0x20000
    s_mov_b32 s46, 3584
    s_mov_b32 s47, 0x20000
    s_mov_b32 s50, 1835008
    s_mov_b32 s51, 0x20000
    s_mov_b32 s54, 1024
    s_mov_b32 s55, 0x20000
    s_mov_b32 s58, 1024
    s_mov_b32 s59, 0x20000
    s_mov_b32 s62, 2097152
    s_mov_b32 s63, 0x20000
    s_mov_b32 s66, 256
    s_mov_b32 s67, 0x20000
    s_cmp_lg_u32 s5, 1
    s_cbranch_scc1 L_nopf_75
    v_lshlrev_b32 v2, 2, v170
    v_mov_b32 v3, 0
    v_add_u32 v2, 139264, v2
    ds_write_b32 v2, v3
L_nopf_75:
    v_lshrrev_b32 v128, 5, v170
    v_and_b32 v129, 31, v170
    v_bfe_u32 v130, v170, 1, 3
    v_xor_b32 v130, v130, v128
    v_lshlrev_b32 v130, 4, v130
    v_lshl_add_u32 v246, v129, 7, v130
    s_lshl_b32 s13, s5, 12
    s_add_u32 s13, s13, 65536
    v_add_u32 v246, s13, v246
    v_xor_b32 v247, 32, v246
    v_xor_b32 v248, 64, v246
    v_xor_b32 v249, 96, v246
    v_lshlrev_b32 v250, 4, v170
    s_lshl_b32 s13, s5, 10
    v_add_u32 v251, s13, v250
    v_lshlrev_b32 v128, 4, v128
    v_cvt_f32_u32 v128, v128
    s_lshl_b32 s13, s5, 5
    s_and_b32 s14, s2, 1
    s_lshl_b32 s15, s14, 10
    v_add_u32 v130, s13, v129
    v_and_b32 v132, 1, v130
    v_and_b32 v131, 0xfffe, v130
    v_add_u32 v131, s14, v131
    v_cvt_f32_u32 v132, v132
    v_fma_f32 v244, v132, 2.0, -1.0
    v_sub_f32 v160, 0, v244
    v_mul_f32 v132, 0x3e800000, v132
    v_mov_b32 v133, v132
    v_add_u32 v135, s15, v129
    v_cmp_eq_u32 vcc, 1, v135
    s_nop 1
    v_cndmask_b32 v242, v160, 0, vcc
    v_cndmask_b32 v240, 1.0, 0, vcc
    v_add_u32 v135, s15, v130
    v_cmp_eq_u32 vcc, 1, v135
    v_mov_b32 v130, 0x80
    s_nop 0
    v_cndmask_b32 v131, v131, v130, vcc
    v_cndmask_b32 v132, v132, 0, vcc
    v_cvt_f32_u32 v131, v131
    v_mul_f32 v131, 0x3b000000, v131
    v_mul_f32 v134, 0x42000000, v131
    v_cos_f32 v136, v134
    v_fma_f32 v8, v128, v131, v132
    v_fma_f32 v24, v128, v131, v133
    v_add_f32 v24, v24, v131
    v_add_f32 v131, v131, v131
    v_add_f32 v136, v136, v136
    v_add_f32 v9, v8, v131
    v_add_f32 v10, v9, v131
    v_add_f32 v11, v10, v131
    v_add_f32 v12, v11, v131
    v_add_f32 v13, v12, v131
    v_add_f32 v14, v13, v131
    v_add_f32 v15, v14, v131
    v_add_f32 v16, v8, v134
    v_add_f32 v17, v9, v134
    v_add_f32 v18, v10, v134
    v_add_f32 v19, v11, v134
    v_add_f32 v20, v12, v134
    v_add_f32 v21, v13, v134
    v_add_f32 v22, v14, v134
    v_add_f32 v23, v15, v134
    v_cos_f32 v8, v8
    v_cos_f32 v9, v9
    v_cos_f32 v10, v10
    v_cos_f32 v11, v11
    v_cos_f32 v12, v12
    v_cos_f32 v13, v13
    v_cos_f32 v14, v14
    v_cos_f32 v15, v15
    v_cos_f32 v16, v16
    v_cos_f32 v17, v17
    v_cos_f32 v18, v18
    v_cos_f32 v19, v19
    v_cos_f32 v20, v20
    v_cos_f32 v21, v21
    v_cos_f32 v22, v22
    v_cos_f32 v23, v23
    v_add_f32 v25, v24, v131
    v_add_f32 v26, v25, v131
    v_add_f32 v27, v26, v131
    v_add_f32 v28, v27, v131
    v_add_f32 v29, v28, v131
    v_add_f32 v30, v29, v131
    v_add_f32 v31, v30, v131
    v_add_f32 v32, v24, v134
    v_add_f32 v33, v25, v134
    v_add_f32 v34, v26, v134
    v_add_f32 v35, v27, v134
    v_add_f32 v36, v28, v134
    v_add_f32 v37, v29, v134
    v_add_f32 v38, v30, v134
    v_add_f32 v39, v31, v134
    v_cos_f32 v24, v24
    v_cos_f32 v25, v25
    v_cos_f32 v26, v26
    v_cos_f32 v27, v27
    v_cos_f32 v28, v28
    v_cos_f32 v29, v29
    v_cos_f32 v30, v30
    v_cos_f32 v31, v31
    v_cos_f32 v32, v32
    v_cos_f32 v33, v33
    v_cos_f32 v34, v34
    v_cos_f32 v35, v35
    v_cos_f32 v36, v36
    v_cos_f32 v37, v37
    v_cos_f32 v38, v38
    v_cos_f32 v39, v39
    s_mov_b32 s13, 0
    s_branch L_bs_77
L_bg_76:
    v_fma_f32 v8, v136, v16, -v8
    v_fma_f32 v9, v136, v17, -v9
    v_fma_f32 v10, v136, v18, -v10
    v_fma_f32 v11, v136, v19, -v11
    v_fma_f32 v12, v136, v20, -v12
    v_fma_f32 v13, v136, v21, -v13
    v_fma_f32 v14, v136, v22, -v14
    v_fma_f32 v15, v136, v23, -v15
    v_fma_f32 v24, v136, v32, -v24
    v_fma_f32 v25, v136, v33, -v25
    v_fma_f32 v26, v136, v34, -v26
    v_fma_f32 v27, v136, v35, -v27
    v_fma_f32 v28, v136, v36, -v28
    v_fma_f32 v29, v136, v37, -v29
    v_fma_f32 v30, v136, v38, -v30
    v_fma_f32 v31, v136, v39, -v31
    v_fma_f32 v16, v136, v8, -v16
    v_fma_f32 v17, v136, v9, -v17
    v_fma_f32 v18, v136, v10, -v18
    v_fma_f32 v19, v136, v11, -v19
    v_fma_f32 v20, v136, v12, -v20
    v_fma_f32 v21, v136, v13, -v21
    v_fma_f32 v22, v136, v14, -v22
    v_fma_f32 v23, v136, v15, -v23
    v_fma_f32 v32, v136, v24, -v32
    v_fma_f32 v33, v136, v25, -v33
    v_fma_f32 v34, v136, v26, -v34
    v_fma_f32 v35, v136, v27, -v35
    v_fma_f32 v36, v136, v28, -v36
    v_fma_f32 v37, v136, v29, -v37
    v_fma_f32 v38, v136, v30, -v38
    v_fma_f32 v39, v136, v31, -v39
L_bs_77:
    s_waitcnt lgkmcnt(0)
    v_cvt_pk_bf16_f32 v48, v8, v9
    v_cvt_pk_bf16_f32 v49, v10, v11
    v_cvt_pk_bf16_f32 v50, v12, v13
    v_cvt_pk_bf16_f32 v51, v14, v15
    ds_write_b128 v251, v[48:51] offset:0
    v_cvt_pk_bf16_f32 v52, v24, v25
    v_cvt_pk_bf16_f32 v53, v26, v27
    v_cvt_pk_bf16_f32 v54, v28, v29
    v_cvt_pk_bf16_f32 v55, v30, v31
    ds_write_b128 v251, v[52:55] offset:4096
    v_cvt_pk_bf16_f32 v56, v16, v17
    v_cvt_pk_bf16_f32 v57, v18, v19
    v_cvt_pk_bf16_f32 v58, v20, v21
    v_cvt_pk_bf16_f32 v59, v22, v23
    ds_write_b128 v251, v[56:59] offset:8192
    v_cvt_pk_bf16_f32 v60, v32, v33
    v_cvt_pk_bf16_f32 v61, v34, v35
    v_cvt_pk_bf16_f32 v62, v36, v37
    v_cvt_pk_bf16_f32 v63, v38, v39
    ds_write_b128 v251, v[60:63] offset:12288
    v_add_u32 v251, 16384, v251
    s_add_u32 s13, s13, 1
    s_cmp_lt_u32 s13, 4
    s_cbranch_scc1 L_bg_76
    v_bfe_u32 v128, v170, 3, 1
    v_lshrrev_b32 v129, 5, v170
    v_cmp_eq_u32 vcc, v128, v129
    v_and_b32 v128, 16, v170
    s_mov_b32 s13, 0x3f80
    v_lshlrev_b32 v128, v128, s13
    v_cndmask_b32 v128, 0, v128, vcc
    v_and_b32 v129, 7, v170
    s_lshl_b32 s13, s14, 31
    s_lshr_b32 s15, s13, 16
    s_or_b32 s13, s13, s15
    v_cmp_eq_u32 vcc, 0, v129
    s_nop 1
    v_cndmask_b32 v208, 0, v128, vcc
    v_cmp_eq_u32 vcc, 1, v129
    s_nop 1
    v_cndmask_b32 v209, 0, v128, vcc
    v_cmp_eq_u32 vcc, 2, v129
    s_nop 1
    v_cndmask_b32 v210, 0, v128, vcc
    v_cmp_eq_u32 vcc, 3, v129
    s_nop 1
    v_cndmask_b32 v211, 0, v128, vcc
    v_cmp_eq_u32 vcc, 4, v129
    s_nop 1
    v_cndmask_b32 v212, 0, v128, vcc
    v_cmp_eq_u32 vcc, 5, v129
    s_nop 1
    v_cndmask_b32 v213, 0, v128, vcc
    v_cmp_eq_u32 vcc, 6, v129
    s_nop 1
    v_cndmask_b32 v214, 0, v128, vcc
    v_cmp_eq_u32 vcc, 7, v129
    s_nop 1
    v_cndmask_b32 v215, 0, v128, vcc
    v_xor_b32 v216, s13, v208
    v_xor_b32 v217, s13, v209
    v_xor_b32 v218, s13, v210
    v_xor_b32 v219, s13, v211
    v_xor_b32 v220, s13, v212
    v_xor_b32 v221, s13, v213
    v_xor_b32 v222, s13, v214
    v_xor_b32 v223, s13, v215
    s_waitcnt lgkmcnt(0)
    s_barrier
    ds_read_b128 v[176:179], v246 offset:0
    ds_read_b128 v[180:183], v247 offset:0
    ds_read_b128 v[184:187], v246 offset:16384
    ds_read_b128 v[188:191], v247 offset:16384
    ds_read_b128 v[192:195], v250 offset:0
    ds_read_b128 v[196:199], v250 offset:1024
    ds_read_b128 v[200:203], v250 offset:2048
    s_waitcnt lgkmcnt(6)
    v_mfma_f32_32x32x16_bf16 v[128:143], v[208:211], v[176:179], 0
    s_waitcnt lgkmcnt(5)
    v_mfma_f32_32x32x16_bf16 v[128:143], v[212:215], v[180:183], v[128:143]
    s_waitcnt lgkmcnt(4)
    v_mfma_f32_32x32x16_bf16 v[128:143], v[216:219], v[184:187], v[128:143]
    s_waitcnt lgkmcnt(3)
    v_mfma_f32_32x32x16_bf16 v[128:143], v[220:223], v[188:191], v[128:143]
    s_nop 11
    v_cvt_pk_bf16_f32 v144, v128, v129
    v_cvt_pk_bf16_f32 v145, v130, v131
    v_cvt_pk_bf16_f32 v146, v132, v133
    v_cvt_pk_bf16_f32 v147, v134, v135
    v_cvt_pk_bf16_f32 v148, v136, v137
    v_cvt_pk_bf16_f32 v149, v138, v139
    v_cvt_pk_bf16_f32 v150, v140, v141
    v_cvt_pk_bf16_f32 v151, v142, v143
    ds_read_b128 v[176:179], v248 offset:0
    ds_read_b128 v[204:207], v250 offset:3072
    s_waitcnt lgkmcnt(4)
    v_mfma_f32_32x32x16_bf16 v[0:15], v[144:147], v[192:195], 0
    ds_read_b128 v[180:183], v249 offset:0
    ds_read_b128 v[192:195], v250 offset:4096
    s_waitcnt lgkmcnt(5)
    v_mfma_f32_32x32x16_bf16 v[32:47], v[144:147], v[196:199], 0
    v_bfe_u32 v174, v170, 3, 2
    v_mul_u32_u24 v174, 33280, v174
    v_lshrrev_b32 v175, 5, v170
    v_lshl_add_u32 v174, v175, 7, v174
    v_and_b32 v175, 7, v170
    v_lshl_add_u32 v173, v175, 4, v174
    s_mul_i32 s16, s14, 1064960
    s_lshl_b32 s15, s8, 2
    ds_read_b128 v[184:187], v248 offset:16384
    ds_read_b128 v[196:199], v250 offset:5120
    s_waitcnt lgkmcnt(6)
    v_mfma_f32_32x32x16_bf16 v[64:79], v[144:147], v[200:203], 0
    s_waitcnt lgkmcnt(5)
    v_mfma_f32_32x32x16_bf16 v[128:143], v[208:211], v[176:179], 0
    ds_read_b128 v[188:191], v249 offset:16384
    ds_read_b128 v[200:203], v250 offset:6144
    s_waitcnt lgkmcnt(6)
    v_mfma_f32_32x32x16_bf16 v[96:111], v[144:147], v[204:207], 0
    s_waitcnt lgkmcnt(5)
    v_mfma_f32_32x32x16_bf16 v[128:143], v[212:215], v[180:183], v[128:143]
    ds_read_b128 v[204:207], v250 offset:7168
    s_waitcnt lgkmcnt(5)
    v_mfma_f32_32x32x16_bf16 v[16:31], v[148:151], v[192:195], 0
    s_waitcnt lgkmcnt(4)
    v_mfma_f32_32x32x16_bf16 v[128:143], v[216:219], v[184:187], v[128:143]
    ds_read_b128 v[192:195], v250 offset:8192
    s_waitcnt lgkmcnt(4)
    v_mfma_f32_32x32x16_bf16 v[48:63], v[148:151], v[196:199], 0
    s_waitcnt lgkmcnt(3)
    v_mfma_f32_32x32x16_bf16 v[128:143], v[220:223], v[188:191], v[128:143]
    ds_read_b128 v[196:199], v250 offset:9216
    s_waitcnt lgkmcnt(3)
    v_mfma_f32_32x32x16_bf16 v[80:95], v[148:151], v[200:203], 0
    s_add_u32 s15, s15, s5
    s_lshl_b32 s15, s15, 8
    s_add_u32 s16, s16, s15
    s_add_u32 s16, s16, 3145728
    s_lshr_b32 s13, s7, 2
    s_lshl_b32 s13, s13, 3
    s_add_u32 s13, s13, s6
    s_and_b32 s14, s7, 3
    ds_read_b128 v[200:203], v250 offset:10240
    s_waitcnt lgkmcnt(3)
    v_mfma_f32_32x32x16_bf16 v[112:127], v[148:151], v[204:207], 0
    v_cvt_pk_bf16_f32 v152, v128, v129
    v_cvt_pk_bf16_f32 v153, v130, v131
    v_cvt_pk_bf16_f32 v154, v132, v133
    v_cvt_pk_bf16_f32 v155, v134, v135
    s_barrier
    ds_read_b128 v[176:179], v246 offset:32768
    ds_read_b128 v[204:207], v250 offset:11264
    s_waitcnt lgkmcnt(4)
    v_mfma_f32_32x32x16_bf16 v[0:15], v[152:155], v[192:195], v[0:15]
    v_cvt_pk_bf16_f32 v156, v136, v137
    v_cvt_pk_bf16_f32 v157, v138, v139
    v_cvt_pk_bf16_f32 v158, v140, v141
    v_cvt_pk_bf16_f32 v159, v142, v143
    ds_read_b128 v[180:183], v247 offset:32768
    ds_read_b128 v[192:195], v250 offset:12288
    s_waitcnt lgkmcnt(5)
    v_mfma_f32_32x32x16_bf16 v[32:47], v[152:155], v[196:199], v[32:47]
    v_and_b32 v163, 7, v170
    s_lshl_b32 s15, s5, 1
    v_xor_b32 v162, s15, v163
    v_lshlrev_b32 v162, 4, v162
    v_lshl_add_u32 v162, v163, 9, v162
    v_lshrrev_b32 v164, 3, v170
    v_lshl_add_u32 v162, v164, 1, v162
    v_mul_u32_u24 v164, 8320, v164
    ds_read_b128 v[184:187], v246 offset:49152
    ds_read_b128 v[196:199], v250 offset:13312
    s_waitcnt lgkmcnt(6)
    v_mfma_f32_32x32x16_bf16 v[64:79], v[152:155], v[200:203], v[64:79]
    s_waitcnt lgkmcnt(5)
    v_mfma_f32_32x32x16_bf16 v[128:143], v[208:211], v[176:179], 0
    ds_read_b128 v[188:191], v247 offset:49152
    ds_read_b128 v[200:203], v250 offset:14336
    s_waitcnt lgkmcnt(6)
    v_mfma_f32_32x32x16_bf16 v[96:111], v[152:155], v[204:207], v[96:111]
    s_waitcnt lgkmcnt(5)
    v_mfma_f32_32x32x16_bf16 v[128:143], v[212:215], v[180:183], v[128:143]
    ds_read_b128 v[204:207], v250 offset:15360
    s_waitcnt lgkmcnt(5)
    v_mfma_f32_32x32x16_bf16 v[16:31], v[156:159], v[192:195], v[16:31]
    s_waitcnt lgkmcnt(4)
    v_mfma_f32_32x32x16_bf16 v[128:143], v[216:219], v[184:187], v[128:143]
    ds_read_b128 v[192:195], v250 offset:16384
    s_waitcnt lgkmcnt(4)
    v_mfma_f32_32x32x16_bf16 v[48:63], v[156:159], v[196:199], v[48:63]
    s_waitcnt lgkmcnt(3)
    v_mfma_f32_32x32x16_bf16 v[128:143], v[220:223], v[188:191], v[128:143]
    ds_read_b128 v[196:199], v250 offset:17408
    s_waitcnt lgkmcnt(3)
    v_mfma_f32_32x32x16_bf16 v[80:95], v[156:159], v[200:203], v[80:95]
    v_lshl_add_u32 v164, v163, 4, v164
    v_add_u32 v162, 147456, v162
    v_xor_b32 v163, 16, v162
    s_lshl_b32 s15, s14, 2
    s_add_u32 s15, s15, s5
    s_mul_i32 s15, s15, 133120
    s_lshl_b32 s75, s13, 7
    s_add_u32 s15, s15, s75
    ds_read_b128 v[200:203], v250 offset:18432
    s_waitcnt lgkmcnt(3)
    v_mfma_f32_32x32x16_bf16 v[112:127], v[156:159], v[204:207], v[112:127]
    v_cvt_pk_bf16_f32 v144, v128, v129
    v_cvt_pk_bf16_f32 v145, v130, v131
    v_cvt_pk_bf16_f32 v146, v132, v133
    v_cvt_pk_bf16_f32 v147, v134, v135
    ds_read_b128 v[176:179], v248 offset:32768
    ds_read_b128 v[204:207], v250 offset:19456
    s_waitcnt lgkmcnt(4)
    v_mfma_f32_32x32x16_bf16 v[0:15], v[144:147], v[192:195], v[0:15]
    v_cvt_pk_bf16_f32 v148, v136, v137
    v_cvt_pk_bf16_f32 v149, v138, v139
    v_cvt_pk_bf16_f32 v150, v140, v141
    v_cvt_pk_bf16_f32 v151, v142, v143
    ds_read_b128 v[180:183], v249 offset:32768
    ds_read_b128 v[192:195], v250 offset:20480
    s_waitcnt lgkmcnt(5)
    v_mfma_f32_32x32x16_bf16 v[32:47], v[144:147], v[196:199], v[32:47]
    s_add_u32 s72, s15, 131072
    s_add_u32 s73, s72, 66560
    s_lshl_b32 s15, s5, 2
    s_or_b32 s15, s15, s14
    s_add_u32 s74, s75, 2260992
    s_cmp_eq_u32 s15, 3
    s_cselect_b32 s74, s74, 23068672
    v_and_b32 v165, 31, v170
    ds_read_b128 v[184:187], v248 offset:49152
    ds_read_b128 v[196:199], v250 offset:21504
    s_waitcnt lgkmcnt(6)
    v_mfma_f32_32x32x16_bf16 v[64:79], v[144:147], v[200:203], v[64:79]
    s_waitcnt lgkmcnt(5)
    v_mfma_f32_32x32x16_bf16 v[128:143], v[208:211], v[176:179], 0
    ds_read_b128 v[188:191], v249 offset:49152
    ds_read_b128 v[200:203], v250 offset:22528
    s_waitcnt lgkmcnt(6)
    v_mfma_f32_32x32x16_bf16 v[96:111], v[144:147], v[204:207], v[96:111]
    s_waitcnt lgkmcnt(5)
    v_mfma_f32_32x32x16_bf16 v[128:143], v[212:215], v[180:183], v[128:143]
    ds_read_b128 v[204:207], v250 offset:23552
    s_waitcnt lgkmcnt(5)
    v_mfma_f32_32x32x16_bf16 v[16:31], v[148:151], v[192:195], v[16:31]
    s_waitcnt lgkmcnt(4)
    v_mfma_f32_32x32x16_bf16 v[128:143], v[216:219], v[184:187], v[128:143]
    ds_read_b128 v[192:195], v250 offset:24576
    s_waitcnt lgkmcnt(4)
    v_mfma_f32_32x32x16_bf16 v[48:63], v[148:151], v[196:199], v[48:63]
    s_waitcnt lgkmcnt(3)
    v_mfma_f32_32x32x16_bf16 v[128:143], v[220:223], v[188:191], v[128:143]
    ds_read_b128 v[196:199], v250 offset:25600
    s_waitcnt lgkmcnt(3)
    v_mfma_f32_32x32x16_bf16 v[80:95], v[148:151], v[200:203], v[80:95]
    v_lshlrev_b32 v165, 2, v165
    v_add_u32 v166, 140032, v165
    ds_read_b128 v[200:203], v250 offset:26624
    s_waitcnt lgkmcnt(3)
    v_mfma_f32_32x32x16_bf16 v[112:127], v[148:151], v[204:207], v[112:127]
    s_nop 3
    v_cvt_pk_bf16_f32 v152, v128, v129
    v_cvt_pk_bf16_f32 v153, v130, v131
    v_cvt_pk_bf16_f32 v154, v132, v133
    v_cvt_pk_bf16_f32 v155, v134, v135
    s_barrier
    ds_read_b128 v[176:179], v246 offset:0
    ds_read_b128 v[204:207], v250 offset:27648
    s_waitcnt lgkmcnt(4)
    v_mfma_f32_32x32x16_bf16 v[0:15], v[152:155], v[192:195], v[0:15]
    v_cvt_pk_bf16_f32 v156, v136, v137
    v_cvt_pk_bf16_f32 v157, v138, v139
    v_cvt_pk_bf16_f32 v158, v140, v141
    v_cvt_pk_bf16_f32 v159, v142, v143
    ds_read_b128 v[180:183], v247 offset:0
    ds_read_b128 v[192:195], v250 offset:28672
    s_waitcnt lgkmcnt(5)
    v_mfma_f32_32x32x16_bf16 v[32:47], v[152:155], v[196:199], v[32:47]
    ds_read_b128 v[184:187], v246 offset:16384
    ds_read_b128 v[196:199], v250 offset:29696
    s_waitcnt lgkmcnt(6)
    v_mfma_f32_32x32x16_bf16 v[64:79], v[152:155], v[200:203], v[64:79]
    s_waitcnt lgkmcnt(5)
    v_mfma_f32_32x32x16_bf16 v[128:143], v[208:211], v[176:179], 0
    ds_read_b128 v[188:191], v247 offset:16384
    ds_read_b128 v[200:203], v250 offset:30720
    s_waitcnt lgkmcnt(6)
    v_mfma_f32_32x32x16_bf16 v[96:111], v[152:155], v[204:207], v[96:111]
    s_waitcnt lgkmcnt(5)
    v_mfma_f32_32x32x16_bf16 v[128:143], v[212:215], v[180:183], v[128:143]
    ds_read_b128 v[204:207], v250 offset:31744
    s_waitcnt lgkmcnt(5)
    v_mfma_f32_32x32x16_bf16 v[16:31], v[156:159], v[192:195], v[16:31]
    s_waitcnt lgkmcnt(4)
    v_mfma_f32_32x32x16_bf16 v[128:143], v[216:219], v[184:187], v[128:143]
    ds_read_b128 v[192:195], v250 offset:32768
    s_waitcnt lgkmcnt(4)
    v_mfma_f32_32x32x16_bf16 v[48:63], v[156:159], v[196:199], v[48:63]
    s_waitcnt lgkmcnt(3)
    v_mfma_f32_32x32x16_bf16 v[128:143], v[220:223], v[188:191], v[128:143]
    ds_read_b128 v[196:199], v250 offset:33792
    ds_read_u16 v224, v162 offset:0
    ds_read_u16 v225, v162 offset:128
    ds_read_u16 v226, v162 offset:256
    ds_read_u16 v227, v162 offset:384
    ds_read_b32 v167, v166 offset:0
    s_waitcnt lgkmcnt(8)
    v_mfma_f32_32x32x16_bf16 v[80:95], v[156:159], v[200:203], v[80:95]
    ds_read_b128 v[200:203], v250 offset:34816
    s_waitcnt lgkmcnt(8)
    v_mfma_f32_32x32x16_bf16 v[112:127], v[156:159], v[204:207], v[112:127]
    s_nop 0
    v_cvt_pk_bf16_f32 v144, v128, v129
    v_cvt_pk_bf16_f32 v145, v130, v131
    v_cvt_pk_bf16_f32 v146, v132, v133
    v_cvt_pk_bf16_f32 v147, v134, v135
    ds_read_b128 v[176:179], v248 offset:0
    ds_read_b128 v[204:207], v250 offset:35840
    s_waitcnt lgkmcnt(9)
    v_mfma_f32_32x32x16_bf16 v[0:15], v[144:147], v[192:195], v[0:15]
    v_cvt_pk_bf16_f32 v148, v136, v137
    v_cvt_pk_bf16_f32 v149, v138, v139
    v_cvt_pk_bf16_f32 v150, v140, v141
    v_cvt_pk_bf16_f32 v151, v142, v143
    ds_read_b128 v[180:183], v249 offset:0
    ds_read_b128 v[192:195], v250 offset:36864
    s_waitcnt lgkmcnt(10)
    v_mfma_f32_32x32x16_bf16 v[32:47], v[144:147], v[196:199], v[32:47]
    ds_read_b128 v[184:187], v248 offset:16384
    ds_read_b128 v[196:199], v250 offset:37888
    ds_read_u16 v232, v162 offset:4096
    ds_read_u16 v233, v162 offset:4224
    ds_read_u16 v234, v162 offset:4352
    ds_read_u16 v235, v162 offset:4480
    ds_read_b32 v168, v166 offset:128
    s_waitcnt lgkmcnt(11)
    v_mfma_f32_32x32x16_bf16 v[64:79], v[144:147], v[200:203], v[64:79]
    s_waitcnt lgkmcnt(10)
    v_mfma_f32_32x32x16_bf16 v[128:143], v[208:211], v[176:179], 0
    ds_read_b128 v[188:191], v249 offset:16384
    ds_read_b128 v[200:203], v250 offset:38912
    s_waitcnt lgkmcnt(11)
    v_mfma_f32_32x32x16_bf16 v[96:111], v[144:147], v[204:207], v[96:111]
    s_waitcnt lgkmcnt(10)
    v_mfma_f32_32x32x16_bf16 v[128:143], v[212:215], v[180:183], v[128:143]
    ds_read_b128 v[204:207], v250 offset:39936
    s_waitcnt lgkmcnt(10)
    v_mfma_f32_32x32x16_bf16 v[16:31], v[148:151], v[192:195], v[16:31]
    s_waitcnt lgkmcnt(9)
    v_mfma_f32_32x32x16_bf16 v[128:143], v[216:219], v[184:187], v[128:143]
    ds_read_b128 v[192:195], v250 offset:40960
    s_waitcnt lgkmcnt(9)
    v_mfma_f32_32x32x16_bf16 v[48:63], v[148:151], v[196:199], v[48:63]
    s_waitcnt lgkmcnt(3)
    v_mfma_f32_32x32x16_bf16 v[128:143], v[220:223], v[188:191], v[128:143]
    ds_read_b128 v[196:199], v250 offset:41984
    ds_read_u16 v228, v163 offset:0
    ds_read_u16 v229, v163 offset:128
    ds_read_u16 v230, v163 offset:256
    ds_read_u16 v231, v163 offset:384
    s_waitcnt lgkmcnt(7)
    v_mfma_f32_32x32x16_bf16 v[80:95], v[148:151], v[200:203], v[80:95]
    ds_read_b128 v[200:203], v250 offset:43008
    s_waitcnt lgkmcnt(7)
    v_mfma_f32_32x32x16_bf16 v[112:127], v[148:151], v[204:207], v[112:127]
    s_nop 1
    v_cvt_pk_bf16_f32 v152, v128, v129
    v_cvt_pk_bf16_f32 v153, v130, v131
    v_cvt_pk_bf16_f32 v154, v132, v133
    v_cvt_pk_bf16_f32 v155, v134, v135
    s_barrier
    ds_read_b128 v[176:179], v246 offset:32768
    ds_read_b128 v[204:207], v250 offset:44032
    s_waitcnt lgkmcnt(8)
    v_mfma_f32_32x32x16_bf16 v[0:15], v[152:155], v[192:195], v[0:15]
    v_cvt_pk_bf16_f32 v156, v136, v137
    v_cvt_pk_bf16_f32 v157, v138, v139
    v_cvt_pk_bf16_f32 v158, v140, v141
    v_cvt_pk_bf16_f32 v159, v142, v143
    ds_read_b128 v[180:183], v247 offset:32768
    ds_read_b128 v[192:195], v250 offset:45056
    ds_read_u16 v236, v163 offset:4096
    ds_read_u16 v237, v163 offset:4224
    ds_read_u16 v238, v163 offset:4352
    ds_read_u16 v239, v163 offset:4480
    s_waitcnt lgkmcnt(13)
    v_mfma_f32_32x32x16_bf16 v[32:47], v[152:155], v[196:199], v[32:47]
    ds_read_b128 v[184:187], v246 offset:49152
    ds_read_b128 v[196:199], v250 offset:46080
    s_waitcnt lgkmcnt(10)
    v_mfma_f32_32x32x16_bf16 v[64:79], v[152:155], v[200:203], v[64:79]
    s_waitcnt lgkmcnt(9)
    v_mfma_f32_32x32x16_bf16 v[128:143], v[208:211], v[176:179], 0
    ds_read_b128 v[188:191], v247 offset:49152
    ds_read_b128 v[200:203], v250 offset:47104
    s_waitcnt lgkmcnt(10)
    v_mfma_f32_32x32x16_bf16 v[96:111], v[152:155], v[204:207], v[96:111]
    s_waitcnt lgkmcnt(9)
    v_mfma_f32_32x32x16_bf16 v[128:143], v[212:215], v[180:183], v[128:143]
    ds_read_b128 v[204:207], v250 offset:48128
    s_waitcnt lgkmcnt(9)
    v_mfma_f32_32x32x16_bf16 v[16:31], v[156:159], v[192:195], v[16:31]
    s_waitcnt lgkmcnt(4)
    v_mfma_f32_32x32x16_bf16 v[128:143], v[216:219], v[184:187], v[128:143]
    ds_read_b128 v[192:195], v250 offset:49152
    s_waitcnt lgkmcnt(4)
    v_mfma_f32_32x32x16_bf16 v[48:63], v[156:159], v[196:199], v[48:63]
    s_waitcnt lgkmcnt(3)
    v_mfma_f32_32x32x16_bf16 v[128:143], v[220:223], v[188:191], v[128:143]
    ds_read_b128 v[196:199], v250 offset:50176
    s_waitcnt lgkmcnt(3)
    v_mfma_f32_32x32x16_bf16 v[80:95], v[156:159], v[200:203], v[80:95]
    ds_read_b128 v[200:203], v250 offset:51200
    s_waitcnt lgkmcnt(3)
    v_mfma_f32_32x32x16_bf16 v[112:127], v[156:159], v[204:207], v[112:127]
    s_nop 5
    v_cvt_pk_bf16_f32 v144, v128, v129
    v_cvt_pk_bf16_f32 v145, v130, v131
    v_cvt_pk_bf16_f32 v146, v132, v133
    v_cvt_pk_bf16_f32 v147, v134, v135
    v_lshl_or_b32 v224, v232, 16, v224
    v_lshl_or_b32 v225, v233, 16, v225
    v_lshl_or_b32 v226, v234, 16, v226
    v_lshl_or_b32 v227, v235, 16, v227
    v_lshl_or_b32 v228, v236, 16, v228
    v_lshl_or_b32 v229, v237, 16, v229
    v_lshl_or_b32 v230, v238, 16, v230
    v_lshl_or_b32 v231, v239, 16, v231
    buffer_store_dwordx4 v[224:227], v164, s[68:71], s72 offen sc1
    buffer_store_dwordx4 v[228:231], v164, s[68:71], s73 offen sc1
    v_lshl_or_b32 v167, v168, 16, v167
    s_mov_b64 exec, 0xffffffff
    buffer_store_dword v167, v165, s[68:71], s74 offen sc1
    s_mov_b64 exec, -1
    ds_read_b128 v[176:179], v248 offset:32768
    ds_read_b128 v[204:207], v250 offset:52224
    s_waitcnt lgkmcnt(4)
    v_mfma_f32_32x32x16_bf16 v[0:15], v[144:147], v[192:195], v[0:15]
    v_cvt_pk_bf16_f32 v148, v136, v137
    v_cvt_pk_bf16_f32 v149, v138, v139
    v_cvt_pk_bf16_f32 v150, v140, v141
    v_cvt_pk_bf16_f32 v151, v142, v143
    ds_read_b128 v[180:183], v249 offset:32768
    ds_read_b128 v[192:195], v250 offset:53248
    s_waitcnt lgkmcnt(5)
    v_mfma_f32_32x32x16_bf16 v[32:47], v[144:147], v[196:199], v[32:47]
    ds_read_b128 v[184:187], v248 offset:49152
    ds_read_b128 v[196:199], v250 offset:54272
    s_waitcnt lgkmcnt(6)
    v_mfma_f32_32x32x16_bf16 v[64:79], v[144:147], v[200:203], v[64:79]
    s_waitcnt lgkmcnt(5)
    v_mfma_f32_32x32x16_bf16 v[128:143], v[208:211], v[176:179], 0
    ds_read_b128 v[188:191], v249 offset:49152
    ds_read_b128 v[200:203], v250 offset:55296
    s_waitcnt lgkmcnt(6)
    v_mfma_f32_32x32x16_bf16 v[96:111], v[144:147], v[204:207], v[96:111]
    s_waitcnt lgkmcnt(5)
    v_mfma_f32_32x32x16_bf16 v[128:143], v[212:215], v[180:183], v[128:143]
    ds_read_b128 v[204:207], v250 offset:56320
    s_waitcnt lgkmcnt(5)
    v_mfma_f32_32x32x16_bf16 v[16:31], v[148:151], v[192:195], v[16:31]
    s_waitcnt lgkmcnt(4)
    v_mfma_f32_32x32x16_bf16 v[128:143], v[216:219], v[184:187], v[128:143]
    ds_read_b128 v[192:195], v250 offset:57344
    s_waitcnt lgkmcnt(4)
    v_mfma_f32_32x32x16_bf16 v[48:63], v[148:151], v[196:199], v[48:63]
    s_waitcnt lgkmcnt(3)
    v_mfma_f32_32x32x16_bf16 v[128:143], v[220:223], v[188:191], v[128:143]
    ds_read_b128 v[196:199], v250 offset:58368
    s_waitcnt lgkmcnt(3)
    v_mfma_f32_32x32x16_bf16 v[80:95], v[148:151], v[200:203], v[80:95]
    ds_read_b128 v[200:203], v250 offset:59392
    s_waitcnt lgkmcnt(3)
    v_mfma_f32_32x32x16_bf16 v[112:127], v[148:151], v[204:207], v[112:127]
    s_nop 5
    v_cvt_pk_bf16_f32 v152, v128, v129
    v_cvt_pk_bf16_f32 v153, v130, v131
    v_cvt_pk_bf16_f32 v154, v132, v133
    v_cvt_pk_bf16_f32 v155, v134, v135
    ds_read_b128 v[204:207], v250 offset:60416
    s_waitcnt lgkmcnt(3)
    v_mfma_f32_32x32x16_bf16 v[0:15], v[152:155], v[192:195], v[0:15]
    v_cvt_pk_bf16_f32 v156, v136, v137
    v_cvt_pk_bf16_f32 v157, v138, v139
    v_cvt_pk_bf16_f32 v158, v140, v141
    v_cvt_pk_bf16_f32 v159, v142, v143
    ds_read_b128 v[192:195], v250 offset:61440
    s_waitcnt lgkmcnt(3)
    v_mfma_f32_32x32x16_bf16 v[32:47], v[152:155], v[196:199], v[32:47]
    ds_read_b128 v[196:199], v250 offset:62464
    s_waitcnt lgkmcnt(3)
    v_mfma_f32_32x32x16_bf16 v[64:79], v[152:155], v[200:203], v[64:79]
    ds_read_b128 v[200:203], v250 offset:63488
    s_waitcnt lgkmcnt(3)
    v_mfma_f32_32x32x16_bf16 v[96:111], v[152:155], v[204:207], v[96:111]
    ds_read_b128 v[204:207], v250 offset:64512
    s_waitcnt lgkmcnt(3)
    v_mfma_f32_32x32x16_bf16 v[16:31], v[156:159], v[192:195], v[16:31]
    s_waitcnt lgkmcnt(2)
    v_mfma_f32_32x32x16_bf16 v[48:63], v[156:159], v[196:199], v[48:63]
    s_waitcnt lgkmcnt(1)
    v_mfma_f32_32x32x16_bf16 v[80:95], v[156:159], v[200:203], v[80:95]
    s_waitcnt lgkmcnt(0)
    v_mfma_f32_32x32x16_bf16 v[112:127], v[156:159], v[204:207], v[112:127]
    s_nop 5
    v_pk_fma_f32 v[176:177], v[16:17], v[240:241], v[0:1] op_sel_hi:[1,0,1]
    v_pk_fma_f32 v[178:179], v[18:19], v[240:241], v[2:3] op_sel_hi:[1,0,1]
    v_pk_fma_f32 v[180:181], v[20:21], v[240:241], v[4:5] op_sel_hi:[1,0,1]
    v_pk_fma_f32 v[182:183], v[22:23], v[240:241], v[6:7] op_sel_hi:[1,0,1]
    v_pk_fma_f32 v[184:185], v[24:25], v[240:241], v[8:9] op_sel_hi:[1,0,1]
    v_pk_fma_f32 v[186:187], v[26:27], v[240:241], v[10:11] op_sel_hi:[1,0,1]
    v_pk_fma_f32 v[188:189], v[28:29], v[240:241], v[12:13] op_sel_hi:[1,0,1]
    v_pk_fma_f32 v[190:191], v[30:31], v[240:241], v[14:15] op_sel_hi:[1,0,1]
    v_cvt_pk_bf16_f32 v128, v176, v177
    v_cvt_pk_bf16_f32 v129, v178, v179
    v_cvt_pk_bf16_f32 v130, v180, v181
    v_cvt_pk_bf16_f32 v131, v182, v183
    v_cvt_pk_bf16_f32 v132, v184, v185
    v_cvt_pk_bf16_f32 v133, v186, v187
    v_cvt_pk_bf16_f32 v134, v188, v189
    v_cvt_pk_bf16_f32 v135, v190, v191
    v_mov_b32 v136, v128
    v_mov_b32 v137, v129
    v_mov_b32 v138, v130
    v_mov_b32 v139, v131
    v_mov_b32_dpp v128, v132 row_shr:4 row_mask:0xf bank_mask:0xa
    v_mov_b32_dpp v129, v133 row_shr:4 row_mask:0xf bank_mask:0xa
    v_mov_b32_dpp v130, v134 row_shr:4 row_mask:0xf bank_mask:0xa
    v_mov_b32_dpp v131, v135 row_shr:4 row_mask:0xf bank_mask:0xa
    v_mov_b32_dpp v132, v136 row_shl:4 row_mask:0xf bank_mask:0x5
    v_mov_b32_dpp v133, v137 row_shl:4 row_mask:0xf bank_mask:0x5
    v_mov_b32_dpp v134, v138 row_shl:4 row_mask:0xf bank_mask:0x5
    v_mov_b32_dpp v135, v139 row_shl:4 row_mask:0xf bank_mask:0x5
    s_add_u32 s3, s16, 0
    buffer_store_dwordx4 v[128:131], v173, s[68:71], s3 offen sc1
    s_add_u32 s3, s16, 16640
    buffer_store_dwordx4 v[132:135], v173, s[68:71], s3 offen sc1
    v_pk_mul_f32 v[16:17], v[16:17], v[244:245] op_sel_hi:[1,0]
    v_pk_mul_f32 v[18:19], v[18:19], v[244:245] op_sel_hi:[1,0]
    v_pk_mul_f32 v[20:21], v[20:21], v[244:245] op_sel_hi:[1,0]
    v_pk_mul_f32 v[22:23], v[22:23], v[244:245] op_sel_hi:[1,0]
    v_pk_mul_f32 v[24:25], v[24:25], v[244:245] op_sel_hi:[1,0]
    v_pk_mul_f32 v[26:27], v[26:27], v[244:245] op_sel_hi:[1,0]
    v_pk_mul_f32 v[28:29], v[28:29], v[244:245] op_sel_hi:[1,0]
    v_pk_mul_f32 v[30:31], v[30:31], v[244:245] op_sel_hi:[1,0]
    v_pk_fma_f32 v[176:177], v[0:1], v[242:243], v[16:17] op_sel_hi:[1,0,1]
    v_pk_fma_f32 v[178:179], v[2:3], v[242:243], v[18:19] op_sel_hi:[1,0,1]
    v_pk_fma_f32 v[180:181], v[4:5], v[242:243], v[20:21] op_sel_hi:[1,0,1]
    v_pk_fma_f32 v[182:183], v[6:7], v[242:243], v[22:23] op_sel_hi:[1,0,1]
    v_pk_fma_f32 v[184:185], v[8:9], v[242:243], v[24:25] op_sel_hi:[1,0,1]
    v_pk_fma_f32 v[186:187], v[10:11], v[242:243], v[26:27] op_sel_hi:[1,0,1]
    v_pk_fma_f32 v[188:189], v[12:13], v[242:243], v[28:29] op_sel_hi:[1,0,1]
    v_pk_fma_f32 v[190:191], v[14:15], v[242:243], v[30:31] op_sel_hi:[1,0,1]
    v_cvt_pk_bf16_f32 v140, v176, v177
    v_cvt_pk_bf16_f32 v141, v178, v179
    v_cvt_pk_bf16_f32 v142, v180, v181
    v_cvt_pk_bf16_f32 v143, v182, v183
    v_cvt_pk_bf16_f32 v144, v184, v185
    v_cvt_pk_bf16_f32 v145, v186, v187
    v_cvt_pk_bf16_f32 v146, v188, v189
    v_cvt_pk_bf16_f32 v147, v190, v191
    v_mov_b32 v148, v140
    v_mov_b32 v149, v141
    v_mov_b32 v150, v142
    v_mov_b32 v151, v143
    v_mov_b32_dpp v140, v144 row_shr:4 row_mask:0xf bank_mask:0xa
    v_mov_b32_dpp v141, v145 row_shr:4 row_mask:0xf bank_mask:0xa
    v_mov_b32_dpp v142, v146 row_shr:4 row_mask:0xf bank_mask:0xa
    v_mov_b32_dpp v143, v147 row_shr:4 row_mask:0xf bank_mask:0xa
    v_mov_b32_dpp v144, v148 row_shl:4 row_mask:0xf bank_mask:0x5
    v_mov_b32_dpp v145, v149 row_shl:4 row_mask:0xf bank_mask:0x5
    v_mov_b32_dpp v146, v150 row_shl:4 row_mask:0xf bank_mask:0x5
    v_mov_b32_dpp v147, v151 row_shl:4 row_mask:0xf bank_mask:0x5
    s_add_u32 s3, s16, 532480
    buffer_store_dwordx4 v[140:143], v173, s[68:71], s3 offen sc1
    s_add_u32 s3, s16, 549120
    buffer_store_dwordx4 v[144:147], v173, s[68:71], s3 offen sc1
    s_waitcnt vmcnt(4)
    v_mov_b32 v165, 139264
    v_mov_b32 v166, 1
    s_mov_b64 exec, 1
    ds_add_u32 v165, v166 offset:28
    s_mov_b64 exec, -1
    v_pk_add_f32 v[176:177], v[48:49], v[32:33]
    v_pk_add_f32 v[178:179], v[50:51], v[34:35]
    v_pk_add_f32 v[180:181], v[52:53], v[36:37]
    v_pk_add_f32 v[182:183], v[54:55], v[38:39]
    v_pk_add_f32 v[184:185], v[56:57], v[40:41]
    v_pk_add_f32 v[186:187], v[58:59], v[42:43]
    v_pk_add_f32 v[188:189], v[60:61], v[44:45]
    v_pk_add_f32 v[190:191], v[62:63], v[46:47]
    v_cvt_pk_bf16_f32 v128, v176, v177
    v_cvt_pk_bf16_f32 v129, v178, v179
    v_cvt_pk_bf16_f32 v130, v180, v181
    v_cvt_pk_bf16_f32 v131, v182, v183
    v_cvt_pk_bf16_f32 v132, v184, v185
    v_cvt_pk_bf16_f32 v133, v186, v187
    v_cvt_pk_bf16_f32 v134, v188, v189
    v_cvt_pk_bf16_f32 v135, v190, v191
    v_mov_b32 v136, v128
    v_mov_b32 v137, v129
    v_mov_b32 v138, v130
    v_mov_b32 v139, v131
    v_mov_b32_dpp v128, v132 row_shr:4 row_mask:0xf bank_mask:0xa
    v_mov_b32_dpp v129, v133 row_shr:4 row_mask:0xf bank_mask:0xa
    v_mov_b32_dpp v130, v134 row_shr:4 row_mask:0xf bank_mask:0xa
    v_mov_b32_dpp v131, v135 row_shr:4 row_mask:0xf bank_mask:0xa
    v_mov_b32_dpp v132, v136 row_shl:4 row_mask:0xf bank_mask:0x5
    v_mov_b32_dpp v133, v137 row_shl:4 row_mask:0xf bank_mask:0x5
    v_mov_b32_dpp v134, v138 row_shl:4 row_mask:0xf bank_mask:0x5
    v_mov_b32_dpp v135, v139 row_shl:4 row_mask:0xf bank_mask:0x5
    s_add_u32 s3, s16, 133120
    buffer_store_dwordx4 v[128:131], v173, s[68:71], s3 offen sc1
    s_add_u32 s3, s16, 149760
    buffer_store_dwordx4 v[132:135], v173, s[68:71], s3 offen sc1
    v_pk_mul_f32 v[48:49], v[48:49], v[244:245] op_sel_hi:[1,0]
    v_pk_mul_f32 v[50:51], v[50:51], v[244:245] op_sel_hi:[1,0]
    v_pk_mul_f32 v[52:53], v[52:53], v[244:245] op_sel_hi:[1,0]
    v_pk_mul_f32 v[54:55], v[54:55], v[244:245] op_sel_hi:[1,0]
    v_pk_mul_f32 v[56:57], v[56:57], v[244:245] op_sel_hi:[1,0]
    v_pk_mul_f32 v[58:59], v[58:59], v[244:245] op_sel_hi:[1,0]
    v_pk_mul_f32 v[60:61], v[60:61], v[244:245] op_sel_hi:[1,0]
    v_pk_mul_f32 v[62:63], v[62:63], v[244:245] op_sel_hi:[1,0]
    v_pk_fma_f32 v[176:177], v[32:33], v[160:161], v[48:49] op_sel_hi:[1,0,1]
    v_pk_fma_f32 v[178:179], v[34:35], v[160:161], v[50:51] op_sel_hi:[1,0,1]
    v_pk_fma_f32 v[180:181], v[36:37], v[160:161], v[52:53] op_sel_hi:[1,0,1]
    v_pk_fma_f32 v[182:183], v[38:39], v[160:161], v[54:55] op_sel_hi:[1,0,1]
    v_pk_fma_f32 v[184:185], v[40:41], v[160:161], v[56:57] op_sel_hi:[1,0,1]
    v_pk_fma_f32 v[186:187], v[42:43], v[160:161], v[58:59] op_sel_hi:[1,0,1]
    v_pk_fma_f32 v[188:189], v[44:45], v[160:161], v[60:61] op_sel_hi:[1,0,1]
    v_pk_fma_f32 v[190:191], v[46:47], v[160:161], v[62:63] op_sel_hi:[1,0,1]
    v_cvt_pk_bf16_f32 v140, v176, v177
    v_cvt_pk_bf16_f32 v141, v178, v179
    v_cvt_pk_bf16_f32 v142, v180, v181
    v_cvt_pk_bf16_f32 v143, v182, v183
    v_cvt_pk_bf16_f32 v144, v184, v185
    v_cvt_pk_bf16_f32 v145, v186, v187
    v_cvt_pk_bf16_f32 v146, v188, v189
    v_cvt_pk_bf16_f32 v147, v190, v191
    v_mov_b32 v148, v140
    v_mov_b32 v149, v141
    v_mov_b32 v150, v142
    v_mov_b32 v151, v143
    v_mov_b32_dpp v140, v144 row_shr:4 row_mask:0xf bank_mask:0xa
    v_mov_b32_dpp v141, v145 row_shr:4 row_mask:0xf bank_mask:0xa
    v_mov_b32_dpp v142, v146 row_shr:4 row_mask:0xf bank_mask:0xa
    v_mov_b32_dpp v143, v147 row_shr:4 row_mask:0xf bank_mask:0xa
    v_mov_b32_dpp v144, v148 row_shl:4 row_mask:0xf bank_mask:0x5
    v_mov_b32_dpp v145, v149 row_shl:4 row_mask:0xf bank_mask:0x5
    v_mov_b32_dpp v146, v150 row_shl:4 row_mask:0xf bank_mask:0x5
    v_mov_b32_dpp v147, v151 row_shl:4 row_mask:0xf bank_mask:0x5
    s_add_u32 s3, s16, 665600
    buffer_store_dwordx4 v[140:143], v173, s[68:71], s3 offen sc1
    s_add_u32 s3, s16, 682240
    buffer_store_dwordx4 v[144:147], v173, s[68:71], s3 offen sc1
    v_pk_add_f32 v[176:177], v[80:81], v[64:65]
    v_pk_add_f32 v[178:179], v[82:83], v[66:67]
    v_pk_add_f32 v[180:181], v[84:85], v[68:69]
    v_pk_add_f32 v[182:183], v[86:87], v[70:71]
    v_pk_add_f32 v[184:185], v[88:89], v[72:73]
    v_pk_add_f32 v[186:187], v[90:91], v[74:75]
    v_pk_add_f32 v[188:189], v[92:93], v[76:77]
    v_pk_add_f32 v[190:191], v[94:95], v[78:79]
    v_cvt_pk_bf16_f32 v128, v176, v177
    v_cvt_pk_bf16_f32 v129, v178, v179
    v_cvt_pk_bf16_f32 v130, v180, v181
    v_cvt_pk_bf16_f32 v131, v182, v183
    v_cvt_pk_bf16_f32 v132, v184, v185
    v_cvt_pk_bf16_f32 v133, v186, v187
    v_cvt_pk_bf16_f32 v134, v188, v189
    v_cvt_pk_bf16_f32 v135, v190, v191
    v_mov_b32 v136, v128
    v_mov_b32 v137, v129
    v_mov_b32 v138, v130
    v_mov_b32 v139, v131
    v_mov_b32_dpp v128, v132 row_shr:4 row_mask:0xf bank_mask:0xa
    v_mov_b32_dpp v129, v133 row_shr:4 row_mask:0xf bank_mask:0xa
    v_mov_b32_dpp v130, v134 row_shr:4 row_mask:0xf bank_mask:0xa
    v_mov_b32_dpp v131, v135 row_shr:4 row_mask:0xf bank_mask:0xa
    v_mov_b32_dpp v132, v136 row_shl:4 row_mask:0xf bank_mask:0x5
    v_mov_b32_dpp v133, v137 row_shl:4 row_mask:0xf bank_mask:0x5
    v_mov_b32_dpp v134, v138 row_shl:4 row_mask:0xf bank_mask:0x5
    v_mov_b32_dpp v135, v139 row_shl:4 row_mask:0xf bank_mask:0x5
    s_add_u32 s3, s16, 266240
    buffer_store_dwordx4 v[128:131], v173, s[68:71], s3 offen sc1
    s_add_u32 s3, s16, 282880
    buffer_store_dwordx4 v[132:135], v173, s[68:71], s3 offen sc1
    v_pk_mul_f32 v[80:81], v[80:81], v[244:245] op_sel_hi:[1,0]
    v_pk_mul_f32 v[82:83], v[82:83], v[244:245] op_sel_hi:[1,0]
    v_pk_mul_f32 v[84:85], v[84:85], v[244:245] op_sel_hi:[1,0]
    v_pk_mul_f32 v[86:87], v[86:87], v[244:245] op_sel_hi:[1,0]
    v_pk_mul_f32 v[88:89], v[88:89], v[244:245] op_sel_hi:[1,0]
    v_pk_mul_f32 v[90:91], v[90:91], v[244:245] op_sel_hi:[1,0]
    v_pk_mul_f32 v[92:93], v[92:93], v[244:245] op_sel_hi:[1,0]
    v_pk_mul_f32 v[94:95], v[94:95], v[244:245] op_sel_hi:[1,0]
    v_pk_fma_f32 v[176:177], v[64:65], v[160:161], v[80:81] op_sel_hi:[1,0,1]
    v_pk_fma_f32 v[178:179], v[66:67], v[160:161], v[82:83] op_sel_hi:[1,0,1]
    v_pk_fma_f32 v[180:181], v[68:69], v[160:161], v[84:85] op_sel_hi:[1,0,1]
    v_pk_fma_f32 v[182:183], v[70:71], v[160:161], v[86:87] op_sel_hi:[1,0,1]
    v_pk_fma_f32 v[184:185], v[72:73], v[160:161], v[88:89] op_sel_hi:[1,0,1]
    v_pk_fma_f32 v[186:187], v[74:75], v[160:161], v[90:91] op_sel_hi:[1,0,1]
    v_pk_fma_f32 v[188:189], v[76:77], v[160:161], v[92:93] op_sel_hi:[1,0,1]
    v_pk_fma_f32 v[190:191], v[78:79], v[160:161], v[94:95] op_sel_hi:[1,0,1]
    v_cvt_pk_bf16_f32 v140, v176, v177
    v_cvt_pk_bf16_f32 v141, v178, v179
    v_cvt_pk_bf16_f32 v142, v180, v181
    v_cvt_pk_bf16_f32 v143, v182, v183
    v_cvt_pk_bf16_f32 v144, v184, v185
    v_cvt_pk_bf16_f32 v145, v186, v187
    v_cvt_pk_bf16_f32 v146, v188, v189
    v_cvt_pk_bf16_f32 v147, v190, v191
    v_mov_b32 v148, v140
    v_mov_b32 v149, v141
    v_mov_b32 v150, v142
    v_mov_b32 v151, v143
    v_mov_b32_dpp v140, v144 row_shr:4 row_mask:0xf bank_mask:0xa
    v_mov_b32_dpp v141, v145 row_shr:4 row_mask:0xf bank_mask:0xa
    v_mov_b32_dpp v142, v146 row_shr:4 row_mask:0xf bank_mask:0xa
    v_mov_b32_dpp v143, v147 row_shr:4 row_mask:0xf bank_mask:0xa
    v_mov_b32_dpp v144, v148 row_shl:4 row_mask:0xf bank_mask:0x5
    v_mov_b32_dpp v145, v149 row_shl:4 row_mask:0xf bank_mask:0x5
    v_mov_b32_dpp v146, v150 row_shl:4 row_mask:0xf bank_mask:0x5
    v_mov_b32_dpp v147, v151 row_shl:4 row_mask:0xf bank_mask:0x5
    s_add_u32 s3, s16, 798720
    buffer_store_dwordx4 v[140:143], v173, s[68:71], s3 offen sc1
    s_add_u32 s3, s16, 815360
    buffer_store_dwordx4 v[144:147], v173, s[68:71], s3 offen sc1
    v_pk_add_f32 v[176:177], v[112:113], v[96:97]
    v_pk_add_f32 v[178:179], v[114:115], v[98:99]
    v_pk_add_f32 v[180:181], v[116:117], v[100:101]
    v_pk_add_f32 v[182:183], v[118:119], v[102:103]
    v_pk_add_f32 v[184:185], v[120:121], v[104:105]
    v_pk_add_f32 v[186:187], v[122:123], v[106:107]
    v_pk_add_f32 v[188:189], v[124:125], v[108:109]
    v_pk_add_f32 v[190:191], v[126:127], v[110:111]
    v_cvt_pk_bf16_f32 v128, v176, v177
    v_cvt_pk_bf16_f32 v129, v178, v179
    v_cvt_pk_bf16_f32 v130, v180, v181
    v_cvt_pk_bf16_f32 v131, v182, v183
    v_cvt_pk_bf16_f32 v132, v184, v185
    v_cvt_pk_bf16_f32 v133, v186, v187
    v_cvt_pk_bf16_f32 v134, v188, v189
    v_cvt_pk_bf16_f32 v135, v190, v191
    v_mov_b32 v136, v128
    v_mov_b32 v137, v129
    v_mov_b32 v138, v130
    v_mov_b32 v139, v131
    v_mov_b32_dpp v128, v132 row_shr:4 row_mask:0xf bank_mask:0xa
    v_mov_b32_dpp v129, v133 row_shr:4 row_mask:0xf bank_mask:0xa
    v_mov_b32_dpp v130, v134 row_shr:4 row_mask:0xf bank_mask:0xa
    v_mov_b32_dpp v131, v135 row_shr:4 row_mask:0xf bank_mask:0xa
    v_mov_b32_dpp v132, v136 row_shl:4 row_mask:0xf bank_mask:0x5
    v_mov_b32_dpp v133, v137 row_shl:4 row_mask:0xf bank_mask:0x5
    v_mov_b32_dpp v134, v138 row_shl:4 row_mask:0xf bank_mask:0x5
    v_mov_b32_dpp v135, v139 row_shl:4 row_mask:0xf bank_mask:0x5
    s_add_u32 s3, s16, 399360
    buffer_store_dwordx4 v[128:131], v173, s[68:71], s3 offen sc1
    s_add_u32 s3, s16, 416000
    buffer_store_dwordx4 v[132:135], v173, s[68:71], s3 offen sc1
    v_pk_mul_f32 v[112:113], v[112:113], v[244:245] op_sel_hi:[1,0]
    v_pk_mul_f32 v[114:115], v[114:115], v[244:245] op_sel_hi:[1,0]
    v_pk_mul_f32 v[116:117], v[116:117], v[244:245] op_sel_hi:[1,0]
    v_pk_mul_f32 v[118:119], v[118:119], v[244:245] op_sel_hi:[1,0]
    v_pk_mul_f32 v[120:121], v[120:121], v[244:245] op_sel_hi:[1,0]
    v_pk_mul_f32 v[122:123], v[122:123], v[244:245] op_sel_hi:[1,0]
    v_pk_mul_f32 v[124:125], v[124:125], v[244:245] op_sel_hi:[1,0]
    v_pk_mul_f32 v[126:127], v[126:127], v[244:245] op_sel_hi:[1,0]
    v_pk_fma_f32 v[176:177], v[96:97], v[160:161], v[112:113] op_sel_hi:[1,0,1]
    v_pk_fma_f32 v[178:179], v[98:99], v[160:161], v[114:115] op_sel_hi:[1,0,1]
    v_pk_fma_f32 v[180:181], v[100:101], v[160:161], v[116:117] op_sel_hi:[1,0,1]
    v_pk_fma_f32 v[182:183], v[102:103], v[160:161], v[118:119] op_sel_hi:[1,0,1]
    v_pk_fma_f32 v[184:185], v[104:105], v[160:161], v[120:121] op_sel_hi:[1,0,1]
    v_pk_fma_f32 v[186:187], v[106:107], v[160:161], v[122:123] op_sel_hi:[1,0,1]
    v_pk_fma_f32 v[188:189], v[108:109], v[160:161], v[124:125] op_sel_hi:[1,0,1]
    v_pk_fma_f32 v[190:191], v[110:111], v[160:161], v[126:127] op_sel_hi:[1,0,1]
    v_cvt_pk_bf16_f32 v140, v176, v177
    v_cvt_pk_bf16_f32 v141, v178, v179
    v_cvt_pk_bf16_f32 v142, v180, v181
    v_cvt_pk_bf16_f32 v143, v182, v183
    v_cvt_pk_bf16_f32 v144, v184, v185
    v_cvt_pk_bf16_f32 v145, v186, v187
    v_cvt_pk_bf16_f32 v146, v188, v189
    v_cvt_pk_bf16_f32 v147, v190, v191
    v_mov_b32 v148, v140
    v_mov_b32 v149, v141
    v_mov_b32 v150, v142
    v_mov_b32 v151, v143
    v_mov_b32_dpp v140, v144 row_shr:4 row_mask:0xf bank_mask:0xa
    v_mov_b32_dpp v141, v145 row_shr:4 row_mask:0xf bank_mask:0xa
    v_mov_b32_dpp v142, v146 row_shr:4 row_mask:0xf bank_mask:0xa
    v_mov_b32_dpp v143, v147 row_shr:4 row_mask:0xf bank_mask:0xa
    v_mov_b32_dpp v144, v148 row_shl:4 row_mask:0xf bank_mask:0x5
    v_mov_b32_dpp v145, v149 row_shl:4 row_mask:0xf bank_mask:0x5
    v_mov_b32_dpp v146, v150 row_shl:4 row_mask:0xf bank_mask:0x5
    v_mov_b32_dpp v147, v151 row_shl:4 row_mask:0xf bank_mask:0x5
    s_add_u32 s3, s16, 931840
    buffer_store_dwordx4 v[140:143], v173, s[68:71], s3 offen sc1
    s_add_u32 s3, s16, 948480
    buffer_store_dwordx4 v[144:147], v173, s[68:71], s3 offen sc1
    s_waitcnt vmcnt(0)
    s_mov_b64 exec, 1
    ds_add_u32 v165, v166 offset:36
    s_mov_b64 exec, -1
    s_mov_b32 s81, -1
    s_sub_u32 s13, 256, s12
    s_min_u32 s13, s13, s12
    s_and_b32 s13, s13, 127
    s_and_b32 s14, s12, 1
    s_lshl_b32 s14, s14, 6
    s_lshr_b32 s15, s13, 2
    s_add_u32 s14, s14, s15
    s_cmp_gt_u32 s12, 128
    s_cselect_b32 s15, 32, 0
    s_add_u32 s14, s14, s15
    s_mul_i32 s76, s14, 16640
    s_and_b32 s13, s13, 2
    s_lshl_b32 s13, s13, 4
    s_add_u32 s76, s76, s13
    s_lshl_b32 s13, s5, 12
    s_add_u32 s76, s76, s13
    s_add_u32 s76, s76, 3145728
    s_and_b32 s13, s12, 127
    s_cmp_eq_u32 s13, 0
    s_cselect_b32 s14, 532480, 16
    s_cmp_eq_u32 s12, 128
    s_cselect_b32 s13, 16, 0
    s_add_u32 s76, s76, s13
    s_add_u32 s24, s76, s14
    s_mul_i32 s77, s12, 8320
    s_lshl_b32 s13, s5, 11
    s_add_u32 s77, s77, s13
    s_add_u32 s77, s77, 131072
    s_mul_i32 s78, s12, 8320
    s_lshl_b32 s13, s5, 10
    s_add_u32 s78, s78, s13
    s_add_u32 s78, s78, 131072
    s_cmp_eq_u32 s12, 0
    s_cselect_b32 s80, 1, 0
    s_call_b64 s[26:27], L_fconst
L_cons_common:
    s_lshr_b32 s22, s5, 1
    s_and_b32 s23, s5, 1
    v_lshrrev_b32 v80, 5, v170
    v_lshlrev_b32 v81, 3, v80
    s_lshl_b32 s13, s23, 6
    s_add_u32 s13, s13, 139776
    v_add_u32 v81, s13, v81
    v_mov_b32 v155, v81
    v_lshlrev_b32 v81, 4, v170
    s_lshl_b32 s13, s22, 10
    s_add_u32 s13, s13, 114688
    v_add_u32 v152, s13, v81
    s_lshl_b32 s13, s5, 11
    s_add_u32 s13, s13, 106496
    v_add_u32 v156, s13, v81
    v_bfe_u32 v81, v170, 2, 2
    v_bfe_u32 v82, v170, 4, 1
    v_lshlrev_b32 v82, 5, v82
    v_lshl_add_u32 v82, v81, 7, v82
    v_and_b32 v83, 3, v170
    v_lshl_add_u32 v82, v83, 3, v82
    v_lshrrev_b32 v81, 1, v81
    v_xor_b32 v83, s23, v81
    v_lshl_add_u32 v83, v83, 6, v82
    v_lshl_add_u32 v153, v80, 9, v83
    v_add_u32 v153, 0, v153
    v_add_u32 v154, 65536, v153
    s_add_u32 s13, s5, 1
    s_and_b32 s13, s13, 3
    s_lshl_b32 s13, s13, 11
    s_add_u32 s13, s13, 147456
    v_add_u32 v163, s13, v161
    s_add_u32 s13, s5, 2
    s_and_b32 s13, s13, 3
    s_lshl_b32 s13, s13, 11
    s_add_u32 s13, s13, 147456
    v_add_u32 v158, s13, v161
    s_add_u32 s13, s5, 3
    s_and_b32 s13, s13, 3
    s_lshl_b32 s13, s13, 11
    s_add_u32 s13, s13, 147456
    v_add_u32 v172, s13, v161
    s_cmp_eq_u32 s80, 0
    s_cbranch_scc1 L_nm_78
    s_lshl_b32 s13, s5, 11
    s_add_u32 s13, s13, 98304
    v_add_u32 v161, s13, v161
    v_and_b32 v96, 15, v170
    v_lshrrev_b32 v97, 4, v170
    v_lshl_add_u32 v96, v97, 7, v96
    s_lshl_b32 s13, s5, 9
    s_sub_u32 s13, 2048, s13
    v_sub_u32 v96, s13, v96
    v_subrev_u32 v97, 0, v96
    v_bfe_u32 v98, v97, 9, 2
    v_lshlrev_b32 v157, 11, v98
    v_bfe_u32 v98, v97, 4, 1
    v_lshl_add_u32 v157, v98, 10, v157
    v_bfe_u32 v98, v97, 7, 2
    v_lshl_add_u32 v157, v98, 8, v157
    v_and_b32 v98, 15, v97
    v_lshl_add_u32 v157, v98, 4, v157
    v_bfe_u32 v98, v97, 5, 2
    v_lshl_add_u32 v157, v98, 2, v157
    v_add_u32 v157, 98304, v157
    v_subrev_u32 v97, 32, v96
    v_bfe_u32 v98, v97, 9, 2
    v_lshlrev_b32 v160, 11, v98
    v_bfe_u32 v98, v97, 4, 1
    v_lshl_add_u32 v160, v98, 10, v160
    v_bfe_u32 v98, v97, 7, 2
    v_lshl_add_u32 v160, v98, 8, v160
    v_and_b32 v98, 15, v97
    v_lshl_add_u32 v160, v98, 4, v160
    v_bfe_u32 v98, v97, 5, 2
    v_lshl_add_u32 v160, v98, 2, v160
    v_add_u32 v160, 98304, v160
    v_subrev_u32 v97, 64, v96
    v_bfe_u32 v98, v97, 9, 2
    v_lshlrev_b32 v168, 11, v98
    v_bfe_u32 v98, v97, 4, 1
    v_lshl_add_u32 v168, v98, 10, v168
    v_bfe_u32 v98, v97, 7, 2
    v_lshl_add_u32 v168, v98, 8, v168
    v_and_b32 v98, 15, v97
    v_lshl_add_u32 v168, v98, 4, v168
    v_bfe_u32 v98, v97, 5, 2
    v_lshl_add_u32 v168, v98, 2, v168
    v_add_u32 v168, 98304, v168
    v_subrev_u32 v97, 96, v96
    v_bfe_u32 v98, v97, 9, 2
    v_lshlrev_b32 v169, 11, v98
    v_bfe_u32 v98, v97, 4, 1
    v_lshl_add_u32 v169, v98, 10, v169
    v_bfe_u32 v98, v97, 7, 2
    v_lshl_add_u32 v169, v98, 8, v169
    v_and_b32 v98, 15, v97
    v_lshl_add_u32 v169, v98, 4, v169
    v_bfe_u32 v98, v97, 5, 2
    v_lshl_add_u32 v169, v98, 2, v169
    v_add_u32 v169, 98304, v169
    v_subrev_u32 v97, 16, v96
    v_bfe_u32 v98, v97, 9, 2
    v_lshlrev_b32 v171, 11, v98
    v_bfe_u32 v98, v97, 4, 1
    v_lshl_add_u32 v171, v98, 10, v171
    v_bfe_u32 v98, v97, 7, 2
    v_lshl_add_u32 v171, v98, 8, v171
    v_and_b32 v98, 15, v97
    v_lshl_add_u32 v171, v98, 4, v171
    v_bfe_u32 v98, v97, 5, 2
    v_lshl_add_u32 v171, v98, 2, v171
    v_add_u32 v171, 98304, v171
    v_subrev_u32 v97, 48, v96
    v_bfe_u32 v98, v97, 9, 2
    v_lshlrev_b32 v173, 11, v98
    v_bfe_u32 v98, v97, 4, 1
    v_lshl_add_u32 v173, v98, 10, v173
    v_bfe_u32 v98, v97, 7, 2
    v_lshl_add_u32 v173, v98, 8, v173
    v_and_b32 v98, 15, v97
    v_lshl_add_u32 v173, v98, 4, v173
    v_bfe_u32 v98, v97, 5, 2
    v_lshl_add_u32 v173, v98, 2, v173
    v_add_u32 v173, 98304, v173
    v_subrev_u32 v97, 80, v96
    v_bfe_u32 v98, v97, 9, 2
    v_lshlrev_b32 v174, 11, v98
    v_bfe_u32 v98, v97, 4, 1
    v_lshl_add_u32 v174, v98, 10, v174
    v_bfe_u32 v98, v97, 7, 2
    v_lshl_add_u32 v174, v98, 8, v174
    v_and_b32 v98, 15, v97
    v_lshl_add_u32 v174, v98, 4, v174
    v_bfe_u32 v98, v97, 5, 2
    v_lshl_add_u32 v174, v98, 2, v174
    v_add_u32 v174, 98304, v174
    v_subrev_u32 v97, 112, v96
    v_bfe_u32 v98, v97, 9, 2
    v_lshlrev_b32 v175, 11, v98
    v_bfe_u32 v98, v97, 4, 1
    v_lshl_add_u32 v175, v98, 10, v175
    v_bfe_u32 v98, v97, 7, 2
    v_lshl_add_u32 v175, v98, 8, v175
    v_and_b32 v98, 15, v97
    v_lshl_add_u32 v175, v98, 4, v175
    v_bfe_u32 v98, v97, 5, 2
    v_lshl_add_u32 v175, v98, 2, v175
    v_add_u32 v175, 98304, v175
L_nm_78:
    v_and_b32 v122, 31, v170
    s_lshl_b32 s15, s11, 6
    s_lshl_b32 s16, s23, 5
    s_add_u32 s15, s15, s16
    v_add_u32 v122, s15, v122
    v_cvt_f32_u32 v122, v122
    v_mul_f32 v122, 0x3b000000, v122
    v_lshrrev_b32 v104, 5, v170
    v_cvt_f32_u32 v104, v104
    v_mul_f32 v104, 0x3e800000, v104
    v_mul_f32 v120, 0x41000000, v122
    v_add_f32 v105, v104, v122
    v_add_f32 v106, v105, v122
    v_add_f32 v107, v106, v122
    v_add_f32 v108, v107, v122
    v_add_f32 v109, v108, v122
    v_add_f32 v110, v109, v122
    v_add_f32 v111, v110, v122
    v_add_f32 v112, v104, v120
    v_add_f32 v113, v105, v120
    v_add_f32 v114, v106, v120
    v_add_f32 v115, v107, v120
    v_add_f32 v116, v108, v120
    v_add_f32 v117, v109, v120
    v_add_f32 v118, v110, v120
    v_add_f32 v119, v111, v120
    v_cos_f32 v120, v120
    v_cos_f32 v104, v104
    v_cos_f32 v112, v112
    v_cos_f32 v105, v105
    v_cos_f32 v113, v113
    v_cos_f32 v106, v106
    v_cos_f32 v114, v114
    v_cos_f32 v107, v107
    v_cos_f32 v115, v115
    v_cos_f32 v108, v108
    v_cos_f32 v116, v116
    v_cos_f32 v109, v109
    v_cos_f32 v117, v117
    v_cos_f32 v110, v110
    v_cos_f32 v118, v118
    v_cos_f32 v111, v111
    v_cos_f32 v119, v119
    v_add_f32 v120, v120, v120
    v_lshrrev_b32 v122, 5, v170
    v_and_b32 v122, v122, v170
    v_lshlrev_b32 v122, 15, v122
    v_or_b32 v122, 0x3e00, v122
    s_mov_b32 s17, 0xffff
    v_sub_f32 v121, 0, v120
    v_cvt_pk_bf16_f32 v0, v104, v105
    v_cvt_pk_bf16_f32 v1, v106, v107
    v_cvt_pk_bf16_f32 v2, v108, v109
    v_cvt_pk_bf16_f32 v3, v110, v111
    v_bfi_b32 v0, s17, v122, v0
    v_cvt_pk_bf16_f32 v4, v112, v113
    v_cvt_pk_bf16_f32 v5, v114, v115
    v_cvt_pk_bf16_f32 v6, v116, v117
    v_cvt_pk_bf16_f32 v7, v118, v119
    v_fmac_f32 v104, v121, v112
    v_fmac_f32 v105, v121, v113
    v_fmac_f32 v106, v121, v114
    v_fmac_f32 v107, v121, v115
    v_fmac_f32 v108, v121, v116
    v_fmac_f32 v109, v121, v117
    v_fmac_f32 v110, v121, v118
    v_fmac_f32 v111, v121, v119
    v_cvt_pk_bf16_f32 v8, -v104, -v105
    v_cvt_pk_bf16_f32 v9, -v106, -v107
    v_cvt_pk_bf16_f32 v10, -v108, -v109
    v_cvt_pk_bf16_f32 v11, -v110, -v111
    v_fmac_f32 v112, v120, v104
    v_fmac_f32 v113, v120, v105
    v_fmac_f32 v114, v120, v106
    v_fmac_f32 v115, v120, v107
    v_fmac_f32 v116, v120, v108
    v_fmac_f32 v117, v120, v109
    v_fmac_f32 v118, v120, v110
    v_fmac_f32 v119, v120, v111
    v_cvt_pk_bf16_f32 v12, -v112, -v113
    v_cvt_pk_bf16_f32 v13, -v114, -v115
    v_cvt_pk_bf16_f32 v14, -v116, -v117
    v_cvt_pk_bf16_f32 v15, -v118, -v119
    v_fmac_f32 v104, v121, v112
    v_fmac_f32 v105, v121, v113
    v_fmac_f32 v106, v121, v114
    v_fmac_f32 v107, v121, v115
    v_fmac_f32 v108, v121, v116
    v_fmac_f32 v109, v121, v117
    v_fmac_f32 v110, v121, v118
    v_fmac_f32 v111, v121, v119
    v_cvt_pk_bf16_f32 v16, v104, v105
    v_cvt_pk_bf16_f32 v17, v106, v107
    v_cvt_pk_bf16_f32 v18, v108, v109
    v_cvt_pk_bf16_f32 v19, v110, v111
    v_fmac_f32 v112, v120, v104
    v_fmac_f32 v113, v120, v105
    v_fmac_f32 v114, v120, v106
    v_fmac_f32 v115, v120, v107
    v_fmac_f32 v116, v120, v108
    v_mov_b32 v165, 139264
    v_mov_b32 v166, 1
    s_cmp_eq_u32 s81, -1
    s_cbranch_scc1 L_nosig_79
    s_mov_b32 s3, 0
L_lw_80:
    ds_read_b32 v167, v165 offset:40
    s_add_u32 s3, s3, 1
    s_cmp_gt_u32 s3, 160000
    s_cbranch_scc1 L_lo_81
    s_waitcnt lgkmcnt(0)
    v_cmp_ne_u32 vcc, 1, v167
    s_nop 1
    s_cbranch_vccz L_lo_81
    s_waitcnt lgkmcnt(0)
    s_branch L_lw_80
L_lo_81:
    s_waitcnt vmcnt(0)
    s_lshl_b32 s3, s81, 7
    s_mov_b32 s21, 1
    s_atomic_add s21, s[68:69], s3
L_nosig_79:
    v_fmac_f32 v117, v120, v109
    v_fmac_f32 v118, v120, v110
    v_fmac_f32 v119, v120, v111
    v_cvt_pk_bf16_f32 v20, v112, v113
    v_cvt_pk_bf16_f32 v21, v114, v115
    v_cvt_pk_bf16_f32 v22, v116, v117
    v_cvt_pk_bf16_f32 v23, v118, v119
    v_fmac_f32 v104, v121, v112
    v_fmac_f32 v105, v121, v113
    v_fmac_f32 v106, v121, v114
    v_fmac_f32 v107, v121, v115
    v_fmac_f32 v108, v121, v116
    v_fmac_f32 v109, v121, v117
    v_fmac_f32 v110, v121, v118
    v_fmac_f32 v111, v121, v119
    v_cvt_pk_bf16_f32 v24, -v104, -v105
    v_cvt_pk_bf16_f32 v25, -v106, -v107
    v_cvt_pk_bf16_f32 v26, -v108, -v109
    v_cvt_pk_bf16_f32 v27, -v110, -v111
    v_fmac_f32 v112, v120, v104
    v_fmac_f32 v113, v120, v105
    v_fmac_f32 v114, v120, v106
    v_fmac_f32 v115, v120, v107
    v_fmac_f32 v116, v120, v108
    v_fmac_f32 v117, v120, v109
    v_fmac_f32 v118, v120, v110
    v_fmac_f32 v119, v120, v111
    v_cvt_pk_bf16_f32 v28, -v112, -v113
    v_cvt_pk_bf16_f32 v29, -v114, -v115
    v_cvt_pk_bf16_f32 v30, -v116, -v117
    v_cvt_pk_bf16_f32 v31, -v118, -v119
    v_fmac_f32 v104, v121, v112
    v_fmac_f32 v105, v121, v113
    v_fmac_f32 v106, v121, v114
    v_fmac_f32 v107, v121, v115
    v_fmac_f32 v108, v121, v116
    v_fmac_f32 v109, v121, v117
    v_fmac_f32 v110, v121, v118
    v_fmac_f32 v111, v121, v119
    v_cvt_pk_bf16_f32 v32, v104, v105
    v_cvt_pk_bf16_f32 v33, v106, v107
    v_cvt_pk_bf16_f32 v34, v108, v109
    v_cvt_pk_bf16_f32 v35, v110, v111
    v_fmac_f32 v112, v120, v104
    v_fmac_f32 v113, v120, v105
    v_fmac_f32 v114, v120, v106
    v_fmac_f32 v115, v120, v107
    v_fmac_f32 v116, v120, v108
    v_fmac_f32 v117, v120, v109
    v_fmac_f32 v118, v120, v110
    v_fmac_f32 v119, v120, v111
    v_cvt_pk_bf16_f32 v36, v112, v113
    v_cvt_pk_bf16_f32 v37, v114, v115
    v_cvt_pk_bf16_f32 v38, v116, v117
    v_cvt_pk_bf16_f32 v39, v118, v119
    v_fmac_f32 v104, v121, v112
    v_fmac_f32 v105, v121, v113
    v_fmac_f32 v106, v121, v114
    v_fmac_f32 v107, v121, v115
    v_fmac_f32 v108, v121, v116
    v_fmac_f32 v109, v121, v117
    v_fmac_f32 v110, v121, v118
    v_fmac_f32 v111, v121, v119
    v_cvt_pk_bf16_f32 v40, -v104, -v105
    v_cvt_pk_bf16_f32 v41, -v106, -v107
    v_cvt_pk_bf16_f32 v42, -v108, -v109
    v_cvt_pk_bf16_f32 v43, -v110, -v111
    v_fmac_f32 v112, v120, v104
    v_fmac_f32 v113, v120, v105
    v_fmac_f32 v114, v120, v106
    v_fmac_f32 v115, v120, v107
    v_fmac_f32 v116, v120, v108
    v_fmac_f32 v117, v120, v109
    v_fmac_f32 v118, v120, v110
    v_fmac_f32 v119, v120, v111
    v_cvt_pk_bf16_f32 v44, -v112, -v113
    v_cvt_pk_bf16_f32 v45, -v114, -v115
    v_cvt_pk_bf16_f32 v46, -v116, -v117
    v_cvt_pk_bf16_f32 v47, -v118, -v119
    v_fmac_f32 v104, v121, v112
    v_fmac_f32 v105, v121, v113
    v_fmac_f32 v106, v121, v114
    v_fmac_f32 v107, v121, v115
    v_fmac_f32 v108, v121, v116
    v_fmac_f32 v109, v121, v117
    v_fmac_f32 v110, v121, v118
    v_fmac_f32 v111, v121, v119
    v_cvt_pk_bf16_f32 v48, v104, v105
    v_cvt_pk_bf16_f32 v49, v106, v107
    v_cvt_pk_bf16_f32 v50, v108, v109
    v_cvt_pk_bf16_f32 v51, v110, v111
    v_fmac_f32 v112, v120, v104
    v_fmac_f32 v113, v120, v105
    v_fmac_f32 v114, v120, v106
    v_fmac_f32 v115, v120, v107
    v_fmac_f32 v116, v120, v108
    v_fmac_f32 v117, v120, v109
    v_fmac_f32 v118, v120, v110
    v_fmac_f32 v119, v120, v111
    v_cvt_pk_bf16_f32 v52, v112, v113
    v_cvt_pk_bf16_f32 v53, v114, v115
    v_cvt_pk_bf16_f32 v54, v116, v117
    v_cvt_pk_bf16_f32 v55, v118, v119
    v_fmac_f32 v104, v121, v112
    v_fmac_f32 v105, v121, v113
    v_fmac_f32 v106, v121, v114
    v_fmac_f32 v107, v121, v115
    v_fmac_f32 v108, v121, v116
    v_fmac_f32 v109, v121, v117
    v_fmac_f32 v110, v121, v118
    v_fmac_f32 v111, v121, v119
    v_cvt_pk_bf16_f32 v56, -v104, -v105
    v_cvt_pk_bf16_f32 v57, -v106, -v107
    v_cvt_pk_bf16_f32 v58, -v108, -v109
    v_cvt_pk_bf16_f32 v59, -v110, -v111
    v_fmac_f32 v112, v120, v104
    v_fmac_f32 v113, v120, v105
    v_fmac_f32 v114, v120, v106
    v_fmac_f32 v115, v120, v107
    v_fmac_f32 v116, v120, v108
    v_fmac_f32 v117, v120, v109
    v_fmac_f32 v118, v120, v110
    v_fmac_f32 v119, v120, v111
    v_cvt_pk_bf16_f32 v60, -v112, -v113
    v_cvt_pk_bf16_f32 v61, -v114, -v115
    v_cvt_pk_bf16_f32 v62, -v116, -v117
    v_cvt_pk_bf16_f32 v63, -v118, -v119
    s_mul_i32 s15, s5, 4352
    s_add_u32 s15, s15, 73728
    v_lshl_add_u32 v159, v170, 4, s15
    ds_write_b128 v159, v[104:107] offset:0
    ds_write_b128 v159, v[108:111] offset:1024
    ds_write_b128 v159, v[112:115] offset:2048
    ds_write_b128 v159, v[116:119] offset:3072
    v_lshl_add_u32 v122, v170, 2, s15
    ds_write_b32 v122, v120 offset:4096
    v_and_b32 v80, 15, v170
    v_bfe_u32 v81, v170, 4, 1
    v_lshrrev_b32 v82, 5, v170
    v_lshlrev_b32 v82, 2, v82
    v_lshl_add_u32 v81, v81, 3, v82
    s_bfe_u32 s13, s76, 0x20004
    v_or_b32 v81, s13, v81
    v_xor_b32 v81, v81, v80
    v_lshlrev_b32 v81, 4, v81
    v_and_b32 v82, 7, v80
    v_lshl_add_u32 v81, v82, 8, v81
    v_lshrrev_b32 v82, 3, v80
    v_lshl_add_u32 v81, v82, 13, v81
    s_lshl_b32 s13, s5, 11
    s_add_u32 s13, s13, 147456
    v_add_u32 v144, s13, v81
    v_xor_b32 v145, 16, v144
    v_lshl_add_u32 v81, v170, 4, s13
    v_add_u32 v82, 1024, v81
    s_and_b32 s13, s12, 127
    s_cmp_eq_u32 s13, 0
    s_cselect_b64 vcc, -1, 0
    v_cndmask_b32 v144, v144, v81, vcc
    v_cndmask_b32 v145, v145, v82, vcc
    s_cmp_eq_u32 s80, 0
    s_cbranch_scc1 L_rp_82
    s_mov_b32 s3, 0
L_lw_83:
    ds_read_b32 v167, v165 offset:20
    ds_read_b128 v[96:99], v161 offset:8192
    ds_read_b128 v[100:103], v161 offset:9216
    s_add_u32 s3, s3, 1
    s_cmp_gt_u32 s3, 160000
    s_cbranch_scc1 L_lo_84
    s_waitcnt lgkmcnt(2)
    v_cmp_ne_u32 vcc, 1, v167
    s_nop 1
    s_cbranch_vccz L_lo_84
    s_waitcnt lgkmcnt(0)
    s_branch L_lw_83
L_lo_84:
    s_waitcnt lgkmcnt(0)
    v_lshlrev_b32 v80, 16, v96
    v_and_b32 v88, 0xffff0000, v96
    v_lshlrev_b32 v81, 16, v97
    v_and_b32 v89, 0xffff0000, v97
    v_lshlrev_b32 v82, 16, v98
    v_and_b32 v90, 0xffff0000, v98
    v_lshlrev_b32 v83, 16, v99
    v_and_b32 v91, 0xffff0000, v99
    v_lshlrev_b32 v84, 16, v100
    v_and_b32 v92, 0xffff0000, v100
    v_lshlrev_b32 v85, 16, v101
    v_and_b32 v93, 0xffff0000, v101
    v_lshlrev_b32 v86, 16, v102
    v_and_b32 v94, 0xffff0000, v102
    v_lshlrev_b32 v87, 16, v103
    v_and_b32 v95, 0xffff0000, v103
    ds_read_b32 v96, v157 offset:8192
    ds_read_b32 v97, v160 offset:8192
    ds_read_b32 v98, v168 offset:8192
    ds_read_b32 v99, v169 offset:8192
    ds_read_b32 v100, v171 offset:8192
    ds_read_b32 v101, v173 offset:8192
    ds_read_b32 v102, v174 offset:8192
    ds_read_b32 v103, v175 offset:8192
    ds_read_b128 v[104:107], v161 offset:0
    ds_read_b128 v[108:111], v161 offset:1024
    s_waitcnt lgkmcnt(2)
    ds_read_b32 v112, v157
    ds_read_b32 v113, v160
    ds_read_b32 v114, v168
    ds_read_b32 v115, v169
    ds_read_b32 v116, v171
    ds_read_b32 v117, v173
    ds_read_b32 v118, v174
    ds_read_b32 v119, v175
    v_lshlrev_b32 v120, 16, v96
    v_and_b32 v121, 0xffff0000, v96
    v_add_f32 v80, v80, v120
    v_sub_f32 v88, v88, v121
    v_lshlrev_b32 v120, 16, v97
    v_and_b32 v121, 0xffff0000, v97
    v_add_f32 v81, v81, v120
    v_sub_f32 v89, v89, v121
    v_lshlrev_b32 v120, 16, v98
    v_and_b32 v121, 0xffff0000, v98
    v_add_f32 v82, v82, v120
    v_sub_f32 v90, v90, v121
    v_lshlrev_b32 v120, 16, v99
    v_and_b32 v121, 0xffff0000, v99
    v_add_f32 v83, v83, v120
    v_sub_f32 v91, v91, v121
    v_lshlrev_b32 v120, 16, v100
    v_and_b32 v121, 0xffff0000, v100
    v_add_f32 v84, v84, v120
    v_sub_f32 v92, v92, v121
    v_lshlrev_b32 v120, 16, v101
    v_and_b32 v121, 0xffff0000, v101
    v_add_f32 v85, v85, v120
    v_sub_f32 v93, v93, v121
    v_lshlrev_b32 v120, 16, v102
    v_and_b32 v121, 0xffff0000, v102
    v_add_f32 v86, v86, v120
    v_sub_f32 v94, v94, v121
    v_lshlrev_b32 v120, 16, v103
    v_and_b32 v121, 0xffff0000, v103
    v_add_f32 v87, v87, v120
    v_sub_f32 v95, v95, v121
    s_waitcnt lgkmcnt(0)
    v_lshlrev_b32 v120, 16, v104
    v_and_b32 v121, 0xffff0000, v104
    v_lshlrev_b32 v122, 16, v112
    v_and_b32 v123, 0xffff0000, v112
    v_add_f32 v120, v120, v122
    v_sub_f32 v121, v121, v123
    v_sub_f32 v64, v80, v120
    v_sub_f32 v72, v88, v121
    v_add_f32 v80, v80, v120
    v_add_f32 v88, v88, v121
    v_lshlrev_b32 v120, 16, v105
    v_and_b32 v121, 0xffff0000, v105
    v_lshlrev_b32 v122, 16, v113
    v_and_b32 v123, 0xffff0000, v113
    v_add_f32 v120, v120, v122
    v_sub_f32 v121, v121, v123
    v_sub_f32 v65, v81, v120
    v_sub_f32 v73, v89, v121
    v_add_f32 v81, v81, v120
    v_add_f32 v89, v89, v121
    v_lshlrev_b32 v120, 16, v106
    v_and_b32 v121, 0xffff0000, v106
    v_lshlrev_b32 v122, 16, v114
    v_and_b32 v123, 0xffff0000, v114
    v_add_f32 v120, v120, v122
    v_sub_f32 v121, v121, v123
    v_sub_f32 v66, v82, v120
    v_sub_f32 v74, v90, v121
    v_add_f32 v82, v82, v120
    v_add_f32 v90, v90, v121
    v_lshlrev_b32 v120, 16, v107
    v_and_b32 v121, 0xffff0000, v107
    v_lshlrev_b32 v122, 16, v115
    v_and_b32 v123, 0xffff0000, v115
    v_add_f32 v120, v120, v122
    v_sub_f32 v121, v121, v123
    v_sub_f32 v67, v83, v120
    v_sub_f32 v75, v91, v121
    v_add_f32 v83, v83, v120
    v_add_f32 v91, v91, v121
    v_lshlrev_b32 v120, 16, v108
    v_and_b32 v121, 0xffff0000, v108
    v_lshlrev_b32 v122, 16, v116
    v_and_b32 v123, 0xffff0000, v116
    v_add_f32 v120, v120, v122
    v_sub_f32 v121, v121, v123
    v_sub_f32 v68, v84, v120
    v_sub_f32 v76, v92, v121
    v_add_f32 v84, v84, v120
    v_add_f32 v92, v92, v121
    v_lshlrev_b32 v120, 16, v109
    v_and_b32 v121, 0xffff0000, v109
    v_lshlrev_b32 v122, 16, v117
    v_and_b32 v123, 0xffff0000, v117
    v_add_f32 v120, v120, v122
    v_sub_f32 v121, v121, v123
    v_sub_f32 v69, v85, v120
    v_sub_f32 v77, v93, v121
    v_add_f32 v85, v85, v120
    v_add_f32 v93, v93, v121
    v_lshlrev_b32 v120, 16, v110
    v_and_b32 v121, 0xffff0000, v110
    v_lshlrev_b32 v122, 16, v118
    v_and_b32 v123, 0xffff0000, v118
    v_add_f32 v120, v120, v122
    v_sub_f32 v121, v121, v123
    v_sub_f32 v70, v86, v120
    v_sub_f32 v78, v94, v121
    v_add_f32 v86, v86, v120
    v_add_f32 v94, v94, v121
    v_lshlrev_b32 v120, 16, v111
    v_and_b32 v121, 0xffff0000, v111
    v_lshlrev_b32 v122, 16, v119
    v_and_b32 v123, 0xffff0000, v119
    v_add_f32 v120, v120, v122
    v_sub_f32 v121, v121, v123
    v_sub_f32 v71, v87, v120
    v_sub_f32 v79, v95, v121
    v_add_f32 v87, v87, v120
    v_add_f32 v95, v95, v121
L_rp_82:
    s_mov_b32 s3, 0
L_lw_85:
    ds_read_b32 v167, v165 offset:0
    ds_read_b128 v[104:107], v144
    ds_read_b128 v[108:111], v145
    ds_read_b128 v[96:99], v156
    ds_read_b128 v[100:103], v156 offset:1024
    s_add_u32 s3, s3, 1
    s_cmp_gt_u32 s3, 160000
    s_cbranch_scc1 L_lo_86
    s_waitcnt lgkmcnt(4)
    v_cmp_ne_u32 vcc, 4, v167
    s_nop 1
    s_cbranch_vccz L_lo_86
    s_waitcnt lgkmcnt(0)
    s_branch L_lw_85
L_lo_86:
    s_waitcnt lgkmcnt(0)
    v_mfma_f32_16x16x32_bf16 v[112:115], v[104:107], v[176:179], 0
    v_mfma_f32_16x16x32_bf16 v[116:119], v[108:111], v[176:179], 0
    v_mfma_f32_16x16x32_bf16 v[112:115], v[108:111], v[184:187], v[112:115]
    v_mfma_f32_16x16x32_bf16 v[116:119], v[104:107], v[192:195], v[116:119]
    v_mfma_f32_16x16x32_bf16 v[120:123], v[104:107], v[180:183], 0
    v_mfma_f32_16x16x32_bf16 v[124:127], v[108:111], v[180:183], 0
    v_mfma_f32_16x16x32_bf16 v[120:123], v[108:111], v[188:191], v[120:123]
    v_mfma_f32_16x16x32_bf16 v[124:127], v[104:107], v[196:199], v[124:127]
    s_cmp_eq_u32 s80, 0
    s_cbranch_scc1 L_un_88
    s_nop 4
    s_branch L_nu_87
L_un_88:
    v_lshlrev_b32 v80, 16, v96
    v_and_b32 v88, 0xffff0000, v96
    v_lshlrev_b32 v81, 16, v97
    v_and_b32 v89, 0xffff0000, v97
    v_lshlrev_b32 v82, 16, v98
    v_and_b32 v90, 0xffff0000, v98
    v_lshlrev_b32 v83, 16, v99
    v_and_b32 v91, 0xffff0000, v99
    v_lshlrev_b32 v84, 16, v100
    v_and_b32 v92, 0xffff0000, v100
    v_lshlrev_b32 v85, 16, v101
    v_and_b32 v93, 0xffff0000, v101
    v_lshlrev_b32 v86, 16, v102
    v_and_b32 v94, 0xffff0000, v102
    v_lshlrev_b32 v87, 16, v103
    v_and_b32 v95, 0xffff0000, v103
L_nu_87:
    v_pk_mul_f32 v[128:129], v[112:113], v[224:225]
    v_pk_mul_f32 v[132:133], v[116:117], v[224:225]
    v_pk_mul_f32 v[130:131], v[114:115], v[226:227]
    v_pk_mul_f32 v[134:135], v[118:119], v[226:227]
    v_pk_fma_f32 v[128:129], v[116:117], v[232:233], v[128:129]
    v_pk_fma_f32 v[132:133], v[112:113], v[232:233], v[132:133] neg_lo:[1,0,0] neg_hi:[1,0,0]
    v_pk_fma_f32 v[130:131], v[118:119], v[234:235], v[130:131]
    v_pk_fma_f32 v[134:135], v[114:115], v[234:235], v[134:135] neg_lo:[1,0,0] neg_hi:[1,0,0]
    v_pk_mul_f32 v[136:137], v[120:121], v[228:229]
    v_pk_mul_f32 v[140:141], v[124:125], v[228:229]
    v_pk_mul_f32 v[138:139], v[122:123], v[230:231]
    v_pk_mul_f32 v[142:143], v[126:127], v[230:231]
    v_pk_fma_f32 v[136:137], v[124:125], v[236:237], v[136:137]
    v_pk_fma_f32 v[140:141], v[120:121], v[236:237], v[140:141] neg_lo:[1,0,0] neg_hi:[1,0,0]
    v_pk_fma_f32 v[138:139], v[126:127], v[238:239], v[138:139]
    v_pk_fma_f32 v[142:143], v[122:123], v[238:239], v[142:143] neg_lo:[1,0,0] neg_hi:[1,0,0]
    v_cvt_pk_bf16_f32 v144, v128, v129
    v_cvt_pk_bf16_f32 v145, v130, v131
    v_cvt_pk_bf16_f32 v146, v132, v133
    v_cvt_pk_bf16_f32 v147, v134, v135
    ds_write_b128 v162, v[144:147] offset:0
    v_cvt_pk_bf16_f32 v148, v136, v137
    v_cvt_pk_bf16_f32 v149, v138, v139
    v_cvt_pk_bf16_f32 v150, v140, v141
    v_cvt_pk_bf16_f32 v151, v142, v143
    ds_write_b128 v162, v[148:151] offset:1024
    s_mov_b64 exec, 1
    ds_add_u32 v165, v166 offset:4
    s_mov_b64 exec, -1
    v_mfma_f32_16x16x32_bf16 v[128:131], v[202:205], v[144:147], 0
    v_mfma_f32_16x16x32_bf16 v[132:135], v[200:203], v[144:147], 0
    v_mfma_f32_16x16x32_bf16 v[136:139], v[202:205], v[148:151], 0
    v_mfma_f32_16x16x32_bf16 v[140:143], v[200:203], v[148:151], 0
    s_mov_b32 s3, 0
L_lw_89:
    ds_read_b32 v167, v165 offset:4
    ds_read_b128 v[104:107], v163 offset:0
    ds_read_b128 v[108:111], v163 offset:1024
    ds_read_b128 v[112:115], v158 offset:0
    ds_read_b128 v[116:119], v158 offset:1024
    ds_read_b128 v[120:123], v172 offset:0
    ds_read_b128 v[124:127], v172 offset:1024
    s_add_u32 s3, s3, 1
    s_cmp_gt_u32 s3, 160000
    s_cbranch_scc1 L_lo_90
    s_waitcnt lgkmcnt(6)
    v_cmp_ne_u32 vcc, 4, v167
    s_nop 1
    s_cbranch_vccz L_lo_90
    s_waitcnt lgkmcnt(0)
    s_branch L_lw_89
L_lo_90:
    s_waitcnt lgkmcnt(5)
    v_mfma_f32_16x16x32_bf16 v[128:131], v[208:211], v[104:107], v[128:131]
    v_mfma_f32_16x16x32_bf16 v[132:135], v[206:209], v[104:107], v[132:135]
    s_waitcnt lgkmcnt(4)
    v_mfma_f32_16x16x32_bf16 v[136:139], v[208:211], v[108:111], v[136:139]
    v_mfma_f32_16x16x32_bf16 v[140:143], v[206:209], v[108:111], v[140:143]
    s_waitcnt lgkmcnt(3)
    v_mfma_f32_16x16x32_bf16 v[128:131], v[214:217], v[112:115], v[128:131]
    v_mfma_f32_16x16x32_bf16 v[132:135], v[212:215], v[112:115], v[132:135]
    s_waitcnt lgkmcnt(2)
    v_mfma_f32_16x16x32_bf16 v[136:139], v[214:217], v[116:119], v[136:139]
    v_mfma_f32_16x16x32_bf16 v[140:143], v[212:215], v[116:119], v[140:143]
    s_waitcnt lgkmcnt(1)
    v_mfma_f32_16x16x32_bf16 v[128:131], v[220:223], v[120:123], v[128:131]
    v_mfma_f32_16x16x32_bf16 v[132:135], v[218:221], v[120:123], v[132:135]
    s_waitcnt lgkmcnt(0)
    v_mfma_f32_16x16x32_bf16 v[136:139], v[220:223], v[124:127], v[136:139]
    v_mfma_f32_16x16x32_bf16 v[140:143], v[218:221], v[124:127], v[140:143]
    s_cmp_eq_u32 s80, 0
    s_cbranch_scc1 L_rq_91
    s_nop 2
    v_cvt_pk_bf16_f32 v144, v128, v132
    v_cvt_pk_bf16_f32 v145, v129, v133
    v_cvt_pk_bf16_f32 v146, v130, v134
    v_cvt_pk_bf16_f32 v147, v131, v135
    ds_write_b128 v161, v[144:147] offset:0
    v_cvt_pk_bf16_f32 v148, v136, v140
    v_cvt_pk_bf16_f32 v149, v137, v141
    v_cvt_pk_bf16_f32 v150, v138, v142
    v_cvt_pk_bf16_f32 v151, v139, v143
    ds_write_b128 v161, v[148:151] offset:1024
    s_mov_b64 exec, 1
    ds_add_u32 v165, v166 offset:16
    s_mov_b64 exec, -1
L_rq_91:
    v_pk_mul_f32 v[112:113], v[128:129], v[80:81]
    v_pk_mul_f32 v[116:117], v[132:133], v[80:81]
    v_pk_mul_f32 v[114:115], v[130:131], v[82:83]
    v_pk_mul_f32 v[118:119], v[134:135], v[82:83]
    v_pk_fma_f32 v[112:113], v[132:133], v[88:89], v[112:113] neg_lo:[1,0,0] neg_hi:[1,0,0]
    v_pk_fma_f32 v[116:117], v[128:129], v[88:89], v[116:117]
    v_pk_fma_f32 v[114:115], v[134:135], v[90:91], v[114:115] neg_lo:[1,0,0] neg_hi:[1,0,0]
    v_pk_fma_f32 v[118:119], v[130:131], v[90:91], v[118:119]
    v_pk_mul_f32 v[120:121], v[136:137], v[84:85]
    v_pk_mul_f32 v[124:125], v[140:141], v[84:85]
    v_pk_mul_f32 v[122:123], v[138:139], v[86:87]
    v_pk_mul_f32 v[126:127], v[142:143], v[86:87]
    v_pk_fma_f32 v[120:121], v[140:141], v[92:93], v[120:121] neg_lo:[1,0,0] neg_hi:[1,0,0]
    v_pk_fma_f32 v[124:125], v[136:137], v[92:93], v[124:125]
    v_pk_fma_f32 v[122:123], v[142:143], v[94:95], v[122:123] neg_lo:[1,0,0] neg_hi:[1,0,0]
    v_pk_fma_f32 v[126:127], v[138:139], v[94:95], v[126:127]
    s_cmp_eq_u32 s80, 0
    s_cbranch_scc1 L_rm_92
    s_mov_b32 s3, 0
L_lw_93:
    ds_read_b32 v167, v165 offset:16
    ds_read_b32 v144, v157
    ds_read_b32 v145, v160
    ds_read_b32 v146, v168
    ds_read_b32 v147, v169
    ds_read_b32 v148, v171
    ds_read_b32 v149, v173
    ds_read_b32 v150, v174
    ds_read_b32 v151, v175
    s_add_u32 s3, s3, 1
    s_cmp_gt_u32 s3, 160000
    s_cbranch_scc1 L_lo_94
    s_waitcnt lgkmcnt(8)
    v_cmp_ne_u32 vcc, 4, v167
    s_nop 1
    s_cbranch_vccz L_lo_94
    s_waitcnt lgkmcnt(0)
    s_branch L_lw_93
L_lo_94:
    s_waitcnt lgkmcnt(0)
    v_lshlrev_b32 v96, 16, v144
    v_and_b32 v104, 0xffff0000, v144
    v_lshlrev_b32 v97, 16, v145
    v_and_b32 v105, 0xffff0000, v145
    v_lshlrev_b32 v98, 16, v146
    v_and_b32 v106, 0xffff0000, v146
    v_lshlrev_b32 v99, 16, v147
    v_and_b32 v107, 0xffff0000, v147
    v_lshlrev_b32 v100, 16, v148
    v_and_b32 v108, 0xffff0000, v148
    v_lshlrev_b32 v101, 16, v149
    v_and_b32 v109, 0xffff0000, v149
    v_lshlrev_b32 v102, 16, v150
    v_and_b32 v110, 0xffff0000, v150
    v_lshlrev_b32 v103, 16, v151
    v_and_b32 v111, 0xffff0000, v151
    v_pk_fma_f32 v[112:113], v[96:97], v[64:65], v[112:113]
    v_pk_fma_f32 v[116:117], v[96:97], v[72:73], v[116:117]
    v_pk_fma_f32 v[112:113], v[104:105], v[72:73], v[112:113]
    v_pk_fma_f32 v[116:117], v[104:105], v[64:65], v[116:117] neg_lo:[1,0,0] neg_hi:[1,0,0]
    v_pk_fma_f32 v[114:115], v[98:99], v[66:67], v[114:115]
    v_pk_fma_f32 v[118:119], v[98:99], v[74:75], v[118:119]
    v_pk_fma_f32 v[114:115], v[106:107], v[74:75], v[114:115]
    v_pk_fma_f32 v[118:119], v[106:107], v[66:67], v[118:119] neg_lo:[1,0,0] neg_hi:[1,0,0]
    v_pk_fma_f32 v[120:121], v[100:101], v[68:69], v[120:121]
    v_pk_fma_f32 v[124:125], v[100:101], v[76:77], v[124:125]
    v_pk_fma_f32 v[120:121], v[108:109], v[76:77], v[120:121]
    v_pk_fma_f32 v[124:125], v[108:109], v[68:69], v[124:125] neg_lo:[1,0,0] neg_hi:[1,0,0]
    v_pk_fma_f32 v[122:123], v[102:103], v[70:71], v[122:123]
    v_pk_fma_f32 v[126:127], v[102:103], v[78:79], v[126:127]
    v_pk_fma_f32 v[122:123], v[110:111], v[78:79], v[122:123]
    v_pk_fma_f32 v[126:127], v[110:111], v[70:71], v[126:127] neg_lo:[1,0,0] neg_hi:[1,0,0]
L_rm_92:
    v_cvt_pk_bf16_f32 v144, v112, v113
    v_cvt_pk_bf16_f32 v145, v114, v115
    v_cvt_pk_bf16_f32 v146, -v116, -v117
    v_cvt_pk_bf16_f32 v147, -v118, -v119
    ds_write_b128 v162, v[144:147] offset:8192
    v_cvt_pk_bf16_f32 v148, v120, v121
    v_cvt_pk_bf16_f32 v149, v122, v123
    v_cvt_pk_bf16_f32 v150, -v124, -v125
    v_cvt_pk_bf16_f32 v151, -v126, -v127
    ds_write_b128 v162, v[148:151] offset:9216
    s_mov_b64 exec, 1
    ds_add_u32 v165, v166 offset:8
    s_mov_b64 exec, -1
    v_mfma_f32_16x16x32_bf16 v[128:131], v[144:147], v[202:205], 0
    v_mfma_f32_16x16x32_bf16 v[132:135], v[144:147], v[200:203], 0
    v_mfma_f32_16x16x32_bf16 v[136:139], v[148:151], v[202:205], 0
    v_mfma_f32_16x16x32_bf16 v[140:143], v[148:151], v[200:203], 0
    s_mov_b32 s3, 0
L_lw_95:
    ds_read_b32 v167, v165 offset:8
    ds_read_b128 v[104:107], v163 offset:8192
    ds_read_b128 v[108:111], v163 offset:9216
    ds_read_b128 v[112:115], v158 offset:8192
    ds_read_b128 v[116:119], v158 offset:9216
    ds_read_b128 v[120:123], v172 offset:8192
    ds_read_b128 v[124:127], v172 offset:9216
    s_add_u32 s3, s3, 1
    s_cmp_gt_u32 s3, 160000
    s_cbranch_scc1 L_lo_96
    s_waitcnt lgkmcnt(6)
    v_cmp_ne_u32 vcc, 4, v167
    s_nop 1
    s_cbranch_vccz L_lo_96
    s_waitcnt lgkmcnt(0)
    s_branch L_lw_95
L_lo_96:
    s_waitcnt lgkmcnt(5)
    v_mfma_f32_16x16x32_bf16 v[128:131], v[104:107], v[208:211], v[128:131]
    v_mfma_f32_16x16x32_bf16 v[132:135], v[104:107], v[206:209], v[132:135]
    s_waitcnt lgkmcnt(4)
    v_mfma_f32_16x16x32_bf16 v[136:139], v[108:111], v[208:211], v[136:139]
    v_mfma_f32_16x16x32_bf16 v[140:143], v[108:111], v[206:209], v[140:143]
    s_waitcnt lgkmcnt(3)
    v_mfma_f32_16x16x32_bf16 v[128:131], v[112:115], v[214:217], v[128:131]
    v_mfma_f32_16x16x32_bf16 v[132:135], v[112:115], v[212:215], v[132:135]
    s_waitcnt lgkmcnt(2)
    v_mfma_f32_16x16x32_bf16 v[136:139], v[116:119], v[214:217], v[136:139]
    v_mfma_f32_16x16x32_bf16 v[140:143], v[116:119], v[212:215], v[140:143]
    s_waitcnt lgkmcnt(1)
    v_mfma_f32_16x16x32_bf16 v[128:131], v[120:123], v[220:223], v[128:131]
    v_mfma_f32_16x16x32_bf16 v[132:135], v[120:123], v[218:221], v[132:135]
    s_waitcnt lgkmcnt(0)
    v_mfma_f32_16x16x32_bf16 v[136:139], v[124:127], v[220:223], v[136:139]
    v_mfma_f32_16x16x32_bf16 v[140:143], v[124:127], v[218:221], v[140:143]
    s_nop 3
    v_pk_mul_f32 v[112:113], v[128:129], v[240:241]
    v_pk_mul_f32 v[116:117], v[132:133], v[240:241]
    v_pk_mul_f32 v[114:115], v[130:131], v[242:243]
    v_pk_mul_f32 v[118:119], v[134:135], v[242:243]
    v_pk_fma_f32 v[112:113], v[132:133], v[248:249], v[112:113]
    v_pk_fma_f32 v[116:117], v[128:129], v[248:249], v[116:117] neg_lo:[1,0,0] neg_hi:[1,0,0]
    v_pk_fma_f32 v[114:115], v[134:135], v[250:251], v[114:115]
    v_pk_fma_f32 v[118:119], v[130:131], v[250:251], v[118:119] neg_lo:[1,0,0] neg_hi:[1,0,0]
    v_pk_mul_f32 v[120:121], v[136:137], v[244:245]
    v_pk_mul_f32 v[124:125], v[140:141], v[244:245]
    v_pk_mul_f32 v[122:123], v[138:139], v[246:247]
    v_pk_mul_f32 v[126:127], v[142:143], v[246:247]
    v_pk_fma_f32 v[120:121], v[140:141], v[252:253], v[120:121]
    v_pk_fma_f32 v[124:125], v[136:137], v[252:253], v[124:125] neg_lo:[1,0,0] neg_hi:[1,0,0]
    v_pk_fma_f32 v[122:123], v[142:143], v[254:255], v[122:123]
    v_pk_fma_f32 v[126:127], v[138:139], v[254:255], v[126:127] neg_lo:[1,0,0] neg_hi:[1,0,0]
    v_cvt_pk_bf16_f32 v144, v112, v113
    v_cvt_pk_bf16_f32 v145, v114, v115
    v_cvt_pk_bf16_f32 v146, v120, v121
    v_cvt_pk_bf16_f32 v147, v122, v123
    v_cvt_pk_bf16_f32 v148, v116, v117
    v_cvt_pk_bf16_f32 v149, v118, v119
    v_cvt_pk_bf16_f32 v150, v124, v125
    v_cvt_pk_bf16_f32 v151, v126, v127
    v_mfma_f32_16x16x32_bf16 v[128:131], v[176:179], v[144:147], 0
    v_mfma_f32_16x16x32_bf16 v[136:139], v[180:183], v[144:147], 0
    v_mfma_f32_16x16x32_bf16 v[128:131], v[184:187], v[148:151], v[128:131]
    v_mfma_f32_16x16x32_bf16 v[136:139], v[188:191], v[148:151], v[136:139]
    v_mfma_f32_16x16x32_bf16 v[132:135], v[176:179], v[148:151], 0
    v_mfma_f32_16x16x32_bf16 v[140:143], v[180:183], v[148:151], 0
    v_mfma_f32_16x16x32_bf16 v[132:135], v[192:195], v[144:147], v[132:135]
    v_mfma_f32_16x16x32_bf16 v[140:143], v[196:199], v[144:147], v[140:143]
    s_nop 2
    v_cvt_pk_bf16_f32 v112, v128, v129
    v_cvt_pk_bf16_f32 v113, v130, v131
    v_cvt_pk_bf16_f32 v114, v136, v137
    v_cvt_pk_bf16_f32 v115, v138, v139
    buffer_store_dwordx4 v[112:115], v164, s[68:71], s78 offen sc1
    v_cvt_pk_bf16_f32 v116, -v132, -v133
    v_cvt_pk_bf16_f32 v117, -v134, -v135
    v_cvt_pk_bf16_f32 v118, -v140, -v141
    v_cvt_pk_bf16_f32 v119, -v142, -v143
    s_add_u32 s3, s78, 4096
    buffer_store_dwordx4 v[116:119], v164, s[68:71], s3 offen sc1
    ds_read_b128 v[144:147], v159
    ds_read_b128 v[148:151], v159 offset:1024
    ds_read_b128 v[160:163], v159 offset:2048
    ds_read_b128 v[164:167], v159 offset:3072
    s_mul_i32 s15, s5, 4352
    s_add_u32 s15, s15, 73728
    v_lshl_add_u32 v168, v170, 2, s15
    ds_read_b32 v168, v168 offset:4096
    ds_read_b64 v[232:233], v155 offset:0
    ds_read_b64 v[234:235], v155 offset:16
    ds_read_b64 v[236:237], v155 offset:32
    ds_read_b64 v[238:239], v155 offset:48
    v_bfe_u32 v173, v170, 3, 1
    v_xor_b32 v174, s23, v173
    v_xor_b32 v173, s22, v173
    v_sub_u32 v173, v173, v174
    v_lshl_add_u32 v155, v173, 6, v153
    v_lshrrev_b32 v173, 5, v170
    v_lshl_add_u32 v155, v173, 9, v155
    v_add_u32 v155, 114688, v155
    s_waitcnt lgkmcnt(0)
    s_barrier
    ds_read_b64_tr_b16 v[80:81], v153 offset:0
    ds_read_b64_tr_b16 v[82:83], v153 offset:1024
    ds_read_b128 v[84:87], v152 offset:0
    v_lshlrev_b32 v64, 16, v232
    v_lshlrev_b32 v66, 16, v233
    v_lshlrev_b32 v68, 16, v234
    v_lshlrev_b32 v70, 16, v235
    v_lshlrev_b32 v72, 16, v236
    ds_read_b64_tr_b16 v[88:89], v153 offset:2048
    ds_read_b64_tr_b16 v[90:91], v153 offset:3072
    ds_read_b128 v[92:95], v152 offset:2048
    v_lshlrev_b32 v74, 16, v237
    v_lshlrev_b32 v76, 16, v238
    v_lshlrev_b32 v78, 16, v239
    v_and_b32 v65, 0xffff0000, v232
    v_and_b32 v67, 0xffff0000, v233
    ds_read_b64_tr_b16 v[96:97], v153 offset:4096
    ds_read_b64_tr_b16 v[98:99], v153 offset:5120
    ds_read_b128 v[100:103], v152 offset:4096
    v_and_b32 v69, 0xffff0000, v234
    v_and_b32 v71, 0xffff0000, v235
    v_and_b32 v73, 0xffff0000, v236
    v_and_b32 v75, 0xffff0000, v237
    v_and_b32 v77, 0xffff0000, v238
    ds_read_b64_tr_b16 v[104:105], v153 offset:6144
    ds_read_b64_tr_b16 v[106:107], v153 offset:7168
    ds_read_b128 v[108:111], v152 offset:6144
    v_and_b32 v79, 0xffff0000, v239
    v_sub_f32 v169, 0, v168
    v_fmac_f32 v144, v169, v160
    v_fmac_f32 v145, v169, v161
    v_fmac_f32 v146, v169, v162
    s_barrier
    ds_read_b64_tr_b16 v[112:113], v153 offset:8192
    ds_read_b64_tr_b16 v[114:115], v153 offset:9216
    ds_read_b128 v[116:119], v152 offset:8192
    s_waitcnt lgkmcnt(12)
    v_mfma_f32_32x32x16_bf16 v[240:255], v[80:83], v[84:87], 0
    v_fmac_f32 v147, v169, v163
    v_fmac_f32 v148, v169, v164
    v_fmac_f32 v149, v169, v165
    v_fmac_f32 v150, v169, v166
    v_fmac_f32 v151, v169, v167
    ds_read_b64_tr_b16 v[120:121], v153 offset:10240
    ds_read_b64_tr_b16 v[122:123], v153 offset:11264
    ds_read_b128 v[124:127], v152 offset:10240
    s_waitcnt lgkmcnt(12)
    v_mfma_f32_32x32x16_bf16 v[240:255], v[88:91], v[92:95], v[240:255]
    v_cvt_pk_bf16_f32 v176, v144, v145
    v_cvt_pk_bf16_f32 v177, v146, v147
    v_cvt_pk_bf16_f32 v178, v148, v149
    v_cvt_pk_bf16_f32 v179, v150, v151
    v_fmac_f32 v160, v168, v144
    ds_read_b64_tr_b16 v[128:129], v153 offset:12288
    ds_read_b64_tr_b16 v[130:131], v153 offset:13312
    ds_read_b128 v[132:135], v152 offset:12288
    s_waitcnt lgkmcnt(12)
    v_mfma_f32_32x32x16_bf16 v[240:255], v[96:99], v[100:103], v[240:255]
    v_fmac_f32 v161, v168, v145
    v_fmac_f32 v162, v168, v146
    v_fmac_f32 v163, v168, v147
    v_fmac_f32 v164, v168, v148
    v_fmac_f32 v165, v168, v149
    ds_read_b64_tr_b16 v[136:137], v153 offset:14336
    ds_read_b64_tr_b16 v[138:139], v153 offset:15360
    ds_read_b128 v[140:143], v152 offset:14336
    s_waitcnt lgkmcnt(12)
    v_mfma_f32_32x32x16_bf16 v[240:255], v[104:107], v[108:111], v[240:255]
    v_fmac_f32 v166, v168, v150
    v_fmac_f32 v167, v168, v151
    v_cvt_pk_bf16_f32 v180, v160, v161
    v_cvt_pk_bf16_f32 v181, v162, v163
    v_cvt_pk_bf16_f32 v182, v164, v165
    s_barrier
    ds_read_b64_tr_b16 v[80:81], v153 offset:16384
    ds_read_b64_tr_b16 v[82:83], v153 offset:17408
    ds_read_b128 v[84:87], v152 offset:16384
    s_waitcnt lgkmcnt(12)
    v_mfma_f32_32x32x16_bf16 v[240:255], v[112:115], v[116:119], v[240:255]
    v_cvt_pk_bf16_f32 v183, v166, v167
    v_fmac_f32 v144, v169, v160
    v_fmac_f32 v145, v169, v161
    v_fmac_f32 v146, v169, v162
    v_fmac_f32 v147, v169, v163
    ds_read_b64_tr_b16 v[88:89], v153 offset:18432
    ds_read_b64_tr_b16 v[90:91], v153 offset:19456
    ds_read_b128 v[92:95], v152 offset:18432
    s_waitcnt lgkmcnt(12)
    v_mfma_f32_32x32x16_bf16 v[240:255], v[120:123], v[124:127], v[240:255]
    v_fmac_f32 v148, v169, v164
    v_fmac_f32 v149, v169, v165
    v_fmac_f32 v150, v169, v166
    v_fmac_f32 v151, v169, v167
    v_cvt_pk_bf16_f32 v184, -v144, -v145
    ds_read_b64_tr_b16 v[96:97], v153 offset:20480
    ds_read_b64_tr_b16 v[98:99], v153 offset:21504
    ds_read_b128 v[100:103], v152 offset:20480
    s_waitcnt lgkmcnt(12)
    v_mfma_f32_32x32x16_bf16 v[240:255], v[128:131], v[132:135], v[240:255]
    v_cvt_pk_bf16_f32 v185, -v146, -v147
    v_cvt_pk_bf16_f32 v186, -v148, -v149
    v_cvt_pk_bf16_f32 v187, -v150, -v151
    v_fmac_f32 v160, v168, v144
    v_fmac_f32 v161, v168, v145
    ds_read_b64_tr_b16 v[104:105], v153 offset:22528
    ds_read_b64_tr_b16 v[106:107], v153 offset:23552
    ds_read_b128 v[108:111], v152 offset:22528
    s_waitcnt lgkmcnt(12)
    v_mfma_f32_32x32x16_bf16 v[240:255], v[136:139], v[140:143], v[240:255]
    v_fmac_f32 v162, v168, v146
    v_fmac_f32 v163, v168, v147
    v_fmac_f32 v164, v168, v148
    v_fmac_f32 v165, v168, v149
    v_fmac_f32 v166, v168, v150
    s_waitcnt vmcnt(0)
    s_barrier
    ds_read_b64_tr_b16 v[112:113], v153 offset:24576
    ds_read_b64_tr_b16 v[114:115], v153 offset:25600
    ds_read_b128 v[116:119], v152 offset:32768
    s_waitcnt lgkmcnt(12)
    v_mfma_f32_32x32x16_bf16 v[240:255], v[80:83], v[84:87], v[240:255]
    v_fmac_f32 v167, v168, v151
    v_cvt_pk_bf16_f32 v188, -v160, -v161
    v_cvt_pk_bf16_f32 v189, -v162, -v163
    v_cvt_pk_bf16_f32 v190, -v164, -v165
    v_cvt_pk_bf16_f32 v191, -v166, -v167
    ds_read_b64_tr_b16 v[120:121], v153 offset:26624
    ds_read_b64_tr_b16 v[122:123], v153 offset:27648
    ds_read_b128 v[124:127], v152 offset:34816
    s_waitcnt lgkmcnt(12)
    v_mfma_f32_32x32x16_bf16 v[240:255], v[88:91], v[92:95], v[240:255]
    v_fmac_f32 v144, v169, v160
    v_fmac_f32 v145, v169, v161
    v_fmac_f32 v146, v169, v162
    v_fmac_f32 v147, v169, v163
    v_fmac_f32 v148, v169, v164
    ds_read_b64_tr_b16 v[128:129], v153 offset:28672
    ds_read_b64_tr_b16 v[130:131], v153 offset:29696
    ds_read_b128 v[132:135], v152 offset:36864
    s_waitcnt lgkmcnt(12)
    v_mfma_f32_32x32x16_bf16 v[240:255], v[96:99], v[100:103], v[240:255]
    v_fmac_f32 v149, v169, v165
    v_fmac_f32 v150, v169, v166
    v_fmac_f32 v151, v169, v167
    v_cvt_pk_bf16_f32 v192, v144, v145
    v_cvt_pk_bf16_f32 v193, v146, v147
    ds_read_b64_tr_b16 v[136:137], v153 offset:30720
    ds_read_b64_tr_b16 v[138:139], v153 offset:31744
    ds_read_b128 v[140:143], v152 offset:38912
    s_waitcnt lgkmcnt(12)
    v_mfma_f32_32x32x16_bf16 v[240:255], v[104:107], v[108:111], v[240:255]
    v_cvt_pk_bf16_f32 v194, v148, v149
    v_cvt_pk_bf16_f32 v195, v150, v151
    v_fmac_f32 v160, v168, v144
    v_fmac_f32 v161, v168, v145
    v_fmac_f32 v162, v168, v146
    s_barrier
    ds_read_b64_tr_b16 v[80:81], v153 offset:32768
    ds_read_b64_tr_b16 v[82:83], v153 offset:33792
    ds_read_b128 v[84:87], v152 offset:40960
    s_waitcnt lgkmcnt(12)
    v_mfma_f32_32x32x16_bf16 v[240:255], v[112:115], v[116:119], v[240:255]
    v_fmac_f32 v163, v168, v147
    v_fmac_f32 v164, v168, v148
    v_fmac_f32 v165, v168, v149
    v_fmac_f32 v166, v168, v150
    v_fmac_f32 v167, v168, v151
    ds_read_b64_tr_b16 v[88:89], v153 offset:34816
    ds_read_b64_tr_b16 v[90:91], v153 offset:35840
    ds_read_b128 v[92:95], v152 offset:43008
    s_waitcnt lgkmcnt(12)
    v_mfma_f32_32x32x16_bf16 v[240:255], v[120:123], v[124:127], v[240:255]
    v_cvt_pk_bf16_f32 v196, v160, v161
    v_cvt_pk_bf16_f32 v197, v162, v163
    v_cvt_pk_bf16_f32 v198, v164, v165
    v_cvt_pk_bf16_f32 v199, v166, v167
    v_fmac_f32 v144, v169, v160
    ds_read_b64_tr_b16 v[96:97], v153 offset:36864
    ds_read_b64_tr_b16 v[98:99], v153 offset:37888
    ds_read_b128 v[100:103], v152 offset:45056
    s_waitcnt lgkmcnt(12)
    v_mfma_f32_32x32x16_bf16 v[240:255], v[128:131], v[132:135], v[240:255]
    v_fmac_f32 v145, v169, v161
    v_fmac_f32 v146, v169, v162
    v_fmac_f32 v147, v169, v163
    v_fmac_f32 v148, v169, v164
    v_fmac_f32 v149, v169, v165
    ds_read_b64_tr_b16 v[104:105], v153 offset:38912
    ds_read_b64_tr_b16 v[106:107], v153 offset:39936
    ds_read_b128 v[108:111], v152 offset:47104
    s_waitcnt lgkmcnt(12)
    v_mfma_f32_32x32x16_bf16 v[240:255], v[136:139], v[140:143], v[240:255]
    v_fmac_f32 v150, v169, v166
    v_fmac_f32 v151, v169, v167
    v_cvt_pk_bf16_f32 v200, -v144, -v145
    v_cvt_pk_bf16_f32 v201, -v146, -v147
    v_cvt_pk_bf16_f32 v202, -v148, -v149
    s_barrier
    ds_read_b64_tr_b16 v[112:113], v153 offset:40960
    ds_read_b64_tr_b16 v[114:115], v153 offset:41984
    ds_read_b128 v[116:119], v152 offset:24576
    s_waitcnt lgkmcnt(12)
    v_mfma_f32_32x32x16_bf16 v[240:255], v[80:83], v[84:87], v[240:255]
    ds_read_b64_tr_b16 v[120:121], v153 offset:43008
    ds_read_b64_tr_b16 v[122:123], v153 offset:44032
    ds_read_b128 v[124:127], v152 offset:26624
    s_waitcnt lgkmcnt(12)
    v_mfma_f32_32x32x16_bf16 v[240:255], v[88:91], v[92:95], v[240:255]
    ds_read_b64_tr_b16 v[128:129], v153 offset:45056
    ds_read_b64_tr_b16 v[130:131], v153 offset:46080
    ds_read_b128 v[132:135], v152 offset:28672
    s_waitcnt lgkmcnt(12)
    v_mfma_f32_32x32x16_bf16 v[240:255], v[96:99], v[100:103], v[240:255]
    ds_read_b64_tr_b16 v[136:137], v153 offset:47104
    ds_read_b64_tr_b16 v[138:139], v153 offset:48128
    ds_read_b128 v[140:143], v152 offset:30720
    s_waitcnt lgkmcnt(12)
    v_mfma_f32_32x32x16_bf16 v[240:255], v[104:107], v[108:111], v[240:255]
    s_barrier
    ds_read_b64_tr_b16 v[80:81], v153 offset:49152
    ds_read_b64_tr_b16 v[82:83], v153 offset:50176
    ds_read_b128 v[84:87], v152 offset:0
    s_waitcnt lgkmcnt(12)
    v_mfma_f32_32x32x16_bf16 v[240:255], v[112:115], v[116:119], v[240:255]
    ds_read_b64_tr_b16 v[88:89], v153 offset:51200
    ds_read_b64_tr_b16 v[90:91], v153 offset:52224
    ds_read_b128 v[92:95], v152 offset:2048
    s_waitcnt lgkmcnt(12)
    v_mfma_f32_32x32x16_bf16 v[240:255], v[120:123], v[124:127], v[240:255]
    ds_read_b64_tr_b16 v[96:97], v153 offset:53248
    ds_read_b64_tr_b16 v[98:99], v153 offset:54272
    ds_read_b128 v[100:103], v152 offset:4096
    s_waitcnt lgkmcnt(12)
    v_mfma_f32_32x32x16_bf16 v[240:255], v[128:131], v[132:135], v[240:255]
    ds_read_b64_tr_b16 v[104:105], v153 offset:55296
    ds_read_b64_tr_b16 v[106:107], v153 offset:56320
    ds_read_b128 v[108:111], v152 offset:6144
    s_waitcnt lgkmcnt(12)
    v_mfma_f32_32x32x16_bf16 v[240:255], v[136:139], v[140:143], v[240:255]
    s_barrier
    ds_read_b64_tr_b16 v[112:113], v153 offset:57344
    ds_read_b64_tr_b16 v[114:115], v153 offset:58368
    ds_read_b128 v[116:119], v152 offset:8192
    s_waitcnt lgkmcnt(12)
    v_mfma_f32_32x32x16_bf16 v[240:255], v[80:83], v[84:87], v[240:255]
    ds_read_b64_tr_b16 v[120:121], v153 offset:59392
    ds_read_b64_tr_b16 v[122:123], v153 offset:60416
    ds_read_b128 v[124:127], v152 offset:10240
    s_waitcnt lgkmcnt(12)
    v_mfma_f32_32x32x16_bf16 v[240:255], v[88:91], v[92:95], v[240:255]
    ds_read_b64_tr_b16 v[128:129], v153 offset:61440
    ds_read_b64_tr_b16 v[130:131], v153 offset:62464
    ds_read_b128 v[132:135], v152 offset:12288
    s_waitcnt lgkmcnt(12)
    v_mfma_f32_32x32x16_bf16 v[240:255], v[96:99], v[100:103], v[240:255]
    ds_read_b64_tr_b16 v[136:137], v153 offset:63488
    ds_read_b64_tr_b16 v[138:139], v153 offset:64512
    ds_read_b128 v[140:143], v152 offset:14336
    s_waitcnt lgkmcnt(12)
    v_mfma_f32_32x32x16_bf16 v[240:255], v[104:107], v[108:111], v[240:255]
    s_barrier
    ds_read_b64_tr_b16 v[80:81], v154 offset:0
    ds_read_b64_tr_b16 v[82:83], v154 offset:1024
    ds_read_b128 v[84:87], v152 offset:16384
    s_waitcnt lgkmcnt(12)
    v_mfma_f32_32x32x16_bf16 v[240:255], v[112:115], v[116:119], v[240:255]
    ds_read_b64_tr_b16 v[88:89], v154 offset:2048
    ds_read_b64_tr_b16 v[90:91], v154 offset:3072
    ds_read_b128 v[92:95], v152 offset:18432
    s_waitcnt lgkmcnt(12)
    v_mfma_f32_32x32x16_bf16 v[240:255], v[120:123], v[124:127], v[240:255]
    ds_read_b64_tr_b16 v[96:97], v154 offset:4096
    ds_read_b64_tr_b16 v[98:99], v154 offset:5120
    ds_read_b128 v[100:103], v152 offset:20480
    s_waitcnt lgkmcnt(12)
    v_mfma_f32_32x32x16_bf16 v[240:255], v[128:131], v[132:135], v[240:255]
    ds_read_b64_tr_b16 v[104:105], v154 offset:6144
    ds_read_b64_tr_b16 v[106:107], v154 offset:7168
    ds_read_b128 v[108:111], v152 offset:22528
    s_waitcnt lgkmcnt(12)
    v_mfma_f32_32x32x16_bf16 v[240:255], v[136:139], v[140:143], v[240:255]
    s_barrier
    ds_read_b64_tr_b16 v[112:113], v154 offset:8192
    ds_read_b64_tr_b16 v[114:115], v154 offset:9216
    ds_read_b128 v[116:119], v152 offset:32768
    s_waitcnt lgkmcnt(12)
    v_mfma_f32_32x32x16_bf16 v[240:255], v[80:83], v[84:87], v[240:255]
    ds_read_b64_tr_b16 v[120:121], v154 offset:10240
    ds_read_b64_tr_b16 v[122:123], v154 offset:11264
    ds_read_b128 v[124:127], v152 offset:34816
    s_waitcnt lgkmcnt(12)
    v_mfma_f32_32x32x16_bf16 v[240:255], v[88:91], v[92:95], v[240:255]
    ds_read_b64_tr_b16 v[128:129], v154 offset:12288
    ds_read_b64_tr_b16 v[130:131], v154 offset:13312
    ds_read_b128 v[132:135], v152 offset:36864
    s_waitcnt lgkmcnt(12)
    v_mfma_f32_32x32x16_bf16 v[240:255], v[96:99], v[100:103], v[240:255]
    ds_read_b64_tr_b16 v[136:137], v154 offset:14336
    ds_read_b64_tr_b16 v[138:139], v154 offset:15360
    ds_read_b128 v[140:143], v152 offset:38912
    s_waitcnt lgkmcnt(12)
    v_mfma_f32_32x32x16_bf16 v[240:255], v[104:107], v[108:111], v[240:255]
    s_barrier
    ds_read_b64_tr_b16 v[80:81], v154 offset:16384
    ds_read_b64_tr_b16 v[82:83], v154 offset:17408
    ds_read_b128 v[84:87], v152 offset:40960
    s_waitcnt lgkmcnt(12)
    v_mfma_f32_32x32x16_bf16 v[240:255], v[112:115], v[116:119], v[240:255]
    ds_read_b64_tr_b16 v[88:89], v154 offset:18432
    ds_read_b64_tr_b16 v[90:91], v154 offset:19456
    ds_read_b128 v[92:95], v152 offset:43008
    s_waitcnt lgkmcnt(12)
    v_mfma_f32_32x32x16_bf16 v[240:255], v[120:123], v[124:127], v[240:255]
    ds_read_b64_tr_b16 v[96:97], v154 offset:20480
    ds_read_b64_tr_b16 v[98:99], v154 offset:21504
    ds_read_b128 v[100:103], v152 offset:45056
    s_waitcnt lgkmcnt(12)
    v_mfma_f32_32x32x16_bf16 v[240:255], v[128:131], v[132:135], v[240:255]
    ds_read_b64_tr_b16 v[104:105], v154 offset:22528
    ds_read_b64_tr_b16 v[106:107], v154 offset:23552
    ds_read_b128 v[108:111], v152 offset:47104
    s_waitcnt lgkmcnt(12)
    v_mfma_f32_32x32x16_bf16 v[240:255], v[136:139], v[140:143], v[240:255]
    s_barrier
    ds_read_b64_tr_b16 v[112:113], v154 offset:24576
    ds_read_b64_tr_b16 v[114:115], v154 offset:25600
    ds_read_b128 v[116:119], v152 offset:24576
    s_waitcnt lgkmcnt(12)
    v_mfma_f32_32x32x16_bf16 v[240:255], v[80:83], v[84:87], v[240:255]
    ds_read_b64_tr_b16 v[120:121], v154 offset:26624
    ds_read_b64_tr_b16 v[122:123], v154 offset:27648
    ds_read_b128 v[124:127], v152 offset:26624
    s_waitcnt lgkmcnt(12)
    v_mfma_f32_32x32x16_bf16 v[240:255], v[88:91], v[92:95], v[240:255]
    ds_read_b64_tr_b16 v[128:129], v154 offset:28672
    ds_read_b64_tr_b16 v[130:131], v154 offset:29696
    ds_read_b128 v[132:135], v152 offset:28672
    s_waitcnt lgkmcnt(12)
    v_mfma_f32_32x32x16_bf16 v[240:255], v[96:99], v[100:103], v[240:255]
    ds_read_b64_tr_b16 v[136:137], v154 offset:30720
    ds_read_b64_tr_b16 v[138:139], v154 offset:31744
    ds_read_b128 v[140:143], v152 offset:30720
    s_waitcnt lgkmcnt(12)
    v_mfma_f32_32x32x16_bf16 v[240:255], v[104:107], v[108:111], v[240:255]
    s_barrier
    ds_read_b64_tr_b16 v[80:81], v154 offset:32768
    ds_read_b64_tr_b16 v[82:83], v154 offset:33792
    ds_read_b128 v[84:87], v152 offset:0
    s_waitcnt lgkmcnt(12)
    v_mfma_f32_32x32x16_bf16 v[240:255], v[112:115], v[116:119], v[240:255]
    ds_read_b64_tr_b16 v[88:89], v154 offset:34816
    ds_read_b64_tr_b16 v[90:91], v154 offset:35840
    ds_read_b128 v[92:95], v152 offset:2048
    s_waitcnt lgkmcnt(12)
    v_mfma_f32_32x32x16_bf16 v[240:255], v[120:123], v[124:127], v[240:255]
    ds_read_b64_tr_b16 v[96:97], v154 offset:36864
    ds_read_b64_tr_b16 v[98:99], v154 offset:37888
    ds_read_b128 v[100:103], v152 offset:4096
    s_waitcnt lgkmcnt(12)
    v_mfma_f32_32x32x16_bf16 v[240:255], v[128:131], v[132:135], v[240:255]
    ds_read_b64_tr_b16 v[104:105], v154 offset:38912
    ds_read_b64_tr_b16 v[106:107], v154 offset:39936
    ds_read_b128 v[108:111], v152 offset:6144
    s_waitcnt lgkmcnt(12)
    v_mfma_f32_32x32x16_bf16 v[240:255], v[136:139], v[140:143], v[240:255]
    s_barrier
    ds_read_b64_tr_b16 v[112:113], v154 offset:40960
    ds_read_b64_tr_b16 v[114:115], v154 offset:41984
    ds_read_b128 v[116:119], v152 offset:8192
    s_waitcnt lgkmcnt(12)
    v_mfma_f32_32x32x16_bf16 v[240:255], v[80:83], v[84:87], v[240:255]
    ds_read_b64_tr_b16 v[120:121], v154 offset:43008
    ds_read_b64_tr_b16 v[122:123], v154 offset:44032
    ds_read_b128 v[124:127], v152 offset:10240
    s_waitcnt lgkmcnt(12)
    v_mfma_f32_32x32x16_bf16 v[240:255], v[88:91], v[92:95], v[240:255]
    ds_read_b64_tr_b16 v[128:129], v154 offset:45056
    ds_read_b64_tr_b16 v[130:131], v154 offset:46080
    ds_read_b128 v[132:135], v152 offset:12288
    s_waitcnt lgkmcnt(12)
    v_mfma_f32_32x32x16_bf16 v[240:255], v[96:99], v[100:103], v[240:255]
    ds_read_b64_tr_b16 v[136:137], v154 offset:47104
    ds_read_b64_tr_b16 v[138:139], v154 offset:48128
    ds_read_b128 v[140:143], v152 offset:14336
    s_waitcnt lgkmcnt(12)
    v_mfma_f32_32x32x16_bf16 v[240:255], v[104:107], v[108:111], v[240:255]
    s_barrier
    ds_read_b64_tr_b16 v[80:81], v153 offset:0
    ds_read_b64_tr_b16 v[82:83], v153 offset:1024
    ds_read_b128 v[84:87], v152 offset:16384
    s_waitcnt lgkmcnt(12)
    v_mfma_f32_32x32x16_bf16 v[240:255], v[112:115], v[116:119], v[240:255]
    ds_read_b64_tr_b16 v[88:89], v153 offset:2048
    ds_read_b64_tr_b16 v[90:91], v153 offset:3072
    ds_read_b128 v[92:95], v152 offset:18432
    s_waitcnt lgkmcnt(12)
    v_mfma_f32_32x32x16_bf16 v[240:255], v[120:123], v[124:127], v[240:255]
    ds_read_b64_tr_b16 v[96:97], v153 offset:4096
    ds_read_b64_tr_b16 v[98:99], v153 offset:5120
    ds_read_b128 v[100:103], v152 offset:20480
    s_waitcnt lgkmcnt(12)
    v_mfma_f32_32x32x16_bf16 v[240:255], v[128:131], v[132:135], v[240:255]
    ds_read_b64_tr_b16 v[104:105], v153 offset:6144
    ds_read_b64_tr_b16 v[106:107], v153 offset:7168
    ds_read_b128 v[108:111], v152 offset:22528
    s_waitcnt lgkmcnt(12)
    v_mfma_f32_32x32x16_bf16 v[240:255], v[136:139], v[140:143], v[240:255]
    s_barrier
    s_lshl_b32 s18, s2, 2
    s_add_u32 s18, s18, s5
    s_lshl_b32 s18, s18, 11
    s_add_u32 s18, s18, 18874368
    v_lshlrev_b32 v156, 4, v170
    ds_read_b64_tr_b16 v[112:113], v153 offset:8192
    ds_read_b64_tr_b16 v[114:115], v153 offset:9216
    ds_read_b128 v[116:119], v152 offset:32768
    s_waitcnt lgkmcnt(12)
    v_mfma_f32_32x32x16_bf16 v[64:79], v[80:83], v[84:87], v[64:79]
    s_nop 0
    v_cvt_pk_bf16_f32 v240, v240, v241
    v_cvt_pk_bf16_f32 v241, v242, v243
    ds_read_b64_tr_b16 v[120:121], v153 offset:10240
    ds_read_b64_tr_b16 v[122:123], v153 offset:11264
    ds_read_b128 v[124:127], v152 offset:34816
    s_waitcnt lgkmcnt(12)
    v_mfma_f32_32x32x16_bf16 v[64:79], v[88:91], v[92:95], v[64:79]
    v_cvt_pk_bf16_f32 v242, v244, v245
    v_cvt_pk_bf16_f32 v243, v246, v247
    buffer_store_dwordx4 v[240:243], v156, s[68:71], s18 offen offset:0 sc1
    ds_read_b64_tr_b16 v[128:129], v153 offset:12288
    ds_read_b64_tr_b16 v[130:131], v153 offset:13312
    ds_read_b128 v[132:135], v152 offset:36864
    s_waitcnt lgkmcnt(12)
    v_mfma_f32_32x32x16_bf16 v[64:79], v[96:99], v[100:103], v[64:79]
    v_cvt_pk_bf16_f32 v244, v248, v249
    v_cvt_pk_bf16_f32 v245, v250, v251
    ds_read_b64_tr_b16 v[136:137], v153 offset:14336
    ds_read_b64_tr_b16 v[138:139], v153 offset:15360
    ds_read_b128 v[140:143], v152 offset:38912
    s_waitcnt lgkmcnt(12)
    v_mfma_f32_32x32x16_bf16 v[64:79], v[104:107], v[108:111], v[64:79]
    v_cvt_pk_bf16_f32 v246, v252, v253
    v_cvt_pk_bf16_f32 v247, v254, v255
    buffer_store_dwordx4 v[244:247], v156, s[68:71], s18 offen offset:1024 sc1
    s_barrier
    ds_read_b64_tr_b16 v[80:81], v153 offset:16384
    ds_read_b64_tr_b16 v[82:83], v153 offset:17408
    ds_read_b128 v[84:87], v152 offset:40960
    s_waitcnt lgkmcnt(12)
    v_mfma_f32_32x32x16_bf16 v[64:79], v[112:115], v[116:119], v[64:79]
    ds_read_b64_tr_b16 v[88:89], v153 offset:18432
    ds_read_b64_tr_b16 v[90:91], v153 offset:19456
    ds_read_b128 v[92:95], v152 offset:43008
    s_waitcnt lgkmcnt(12)
    v_mfma_f32_32x32x16_bf16 v[64:79], v[120:123], v[124:127], v[64:79]
    ds_read_b64_tr_b16 v[96:97], v153 offset:20480
    ds_read_b64_tr_b16 v[98:99], v153 offset:21504
    ds_read_b128 v[100:103], v152 offset:45056
    s_waitcnt lgkmcnt(12)
    v_mfma_f32_32x32x16_bf16 v[64:79], v[128:131], v[132:135], v[64:79]
    ds_read_b64_tr_b16 v[104:105], v153 offset:22528
    ds_read_b64_tr_b16 v[106:107], v153 offset:23552
    ds_read_b128 v[108:111], v152 offset:47104
    s_waitcnt lgkmcnt(12)
    v_mfma_f32_32x32x16_bf16 v[64:79], v[136:139], v[140:143], v[64:79]
    s_barrier
    ds_read_b64_tr_b16 v[112:113], v153 offset:24576
    ds_read_b64_tr_b16 v[114:115], v153 offset:25600
    ds_read_b128 v[116:119], v152 offset:24576
    s_waitcnt lgkmcnt(12)
    v_mfma_f32_32x32x16_bf16 v[64:79], v[80:83], v[84:87], v[64:79]
    ds_read_b64_tr_b16 v[120:121], v153 offset:26624
    ds_read_b64_tr_b16 v[122:123], v153 offset:27648
    ds_read_b128 v[124:127], v152 offset:26624
    s_waitcnt lgkmcnt(12)
    v_mfma_f32_32x32x16_bf16 v[64:79], v[88:91], v[92:95], v[64:79]
    ds_read_b64_tr_b16 v[128:129], v153 offset:28672
    ds_read_b64_tr_b16 v[130:131], v153 offset:29696
    ds_read_b128 v[132:135], v152 offset:28672
    s_waitcnt lgkmcnt(12)
    v_mfma_f32_32x32x16_bf16 v[64:79], v[96:99], v[100:103], v[64:79]
    ds_read_b64_tr_b16 v[136:137], v153 offset:30720
    ds_read_b64_tr_b16 v[138:139], v153 offset:31744
    ds_read_b128 v[140:143], v152 offset:30720
    s_waitcnt lgkmcnt(12)
    v_mfma_f32_32x32x16_bf16 v[64:79], v[104:107], v[108:111], v[64:79]
    s_barrier
    ds_read_b64_tr_b16 v[80:81], v153 offset:32768
    ds_read_b64_tr_b16 v[82:83], v153 offset:33792
    ds_read_b128 v[84:87], v152 offset:0
    s_waitcnt lgkmcnt(12)
    v_mfma_f32_32x32x16_bf16 v[64:79], v[112:115], v[116:119], v[64:79]
    ds_read_b64_tr_b16 v[88:89], v153 offset:34816
    ds_read_b64_tr_b16 v[90:91], v153 offset:35840
    ds_read_b128 v[92:95], v152 offset:2048
    s_waitcnt lgkmcnt(12)
    v_mfma_f32_32x32x16_bf16 v[64:79], v[120:123], v[124:127], v[64:79]
    ds_read_b64_tr_b16 v[96:97], v153 offset:36864
    ds_read_b64_tr_b16 v[98:99], v153 offset:37888
    ds_read_b128 v[100:103], v152 offset:4096
    s_waitcnt lgkmcnt(12)
    v_mfma_f32_32x32x16_bf16 v[64:79], v[128:131], v[132:135], v[64:79]
    ds_read_b64_tr_b16 v[104:105], v153 offset:38912
    ds_read_b64_tr_b16 v[106:107], v153 offset:39936
    ds_read_b128 v[108:111], v152 offset:6144
    s_waitcnt lgkmcnt(12)
    v_mfma_f32_32x32x16_bf16 v[64:79], v[136:139], v[140:143], v[64:79]
    s_barrier
    ds_read_b64_tr_b16 v[112:113], v153 offset:40960
    ds_read_b64_tr_b16 v[114:115], v153 offset:41984
    ds_read_b128 v[116:119], v152 offset:8192
    s_waitcnt lgkmcnt(12)
    v_mfma_f32_32x32x16_bf16 v[64:79], v[80:83], v[84:87], v[64:79]
    v_cvt_pk_bf16_f32 v203, -v150, -v151
    v_fmac_f32 v160, v168, v144
    v_fmac_f32 v161, v168, v145
    v_fmac_f32 v162, v168, v146
    v_fmac_f32 v163, v168, v147
    v_fmac_f32 v164, v168, v148
    v_fmac_f32 v165, v168, v149
    v_fmac_f32 v166, v168, v150
    v_fmac_f32 v167, v168, v151
    v_cvt_pk_bf16_f32 v204, -v160, -v161
    v_cvt_pk_bf16_f32 v205, -v162, -v163
    v_cvt_pk_bf16_f32 v206, -v164, -v165
    v_cvt_pk_bf16_f32 v207, -v166, -v167
    v_fmac_f32 v144, v169, v160
    v_fmac_f32 v145, v169, v161
    v_fmac_f32 v146, v169, v162
    v_fmac_f32 v147, v169, v163
    v_fmac_f32 v148, v169, v164
    v_fmac_f32 v149, v169, v165
    v_fmac_f32 v150, v169, v166
    v_fmac_f32 v151, v169, v167
    v_cvt_pk_bf16_f32 v208, v144, v145
    v_cvt_pk_bf16_f32 v209, v146, v147
    v_cvt_pk_bf16_f32 v210, v148, v149
    v_cvt_pk_bf16_f32 v211, v150, v151
    v_fmac_f32 v160, v168, v144
    v_fmac_f32 v161, v168, v145
    v_fmac_f32 v162, v168, v146
    ds_read_b64_tr_b16 v[120:121], v153 offset:43008
    ds_read_b64_tr_b16 v[122:123], v153 offset:44032
    ds_read_b128 v[124:127], v152 offset:10240
    s_waitcnt lgkmcnt(12)
    v_mfma_f32_32x32x16_bf16 v[64:79], v[88:91], v[92:95], v[64:79]
    v_fmac_f32 v163, v168, v147
    v_fmac_f32 v164, v168, v148
    v_fmac_f32 v165, v168, v149
    v_fmac_f32 v166, v168, v150
    v_fmac_f32 v167, v168, v151
    v_cvt_pk_bf16_f32 v212, v160, v161
    v_cvt_pk_bf16_f32 v213, v162, v163
    v_cvt_pk_bf16_f32 v214, v164, v165
    v_cvt_pk_bf16_f32 v215, v166, v167
    v_fmac_f32 v144, v169, v160
    v_fmac_f32 v145, v169, v161
    v_fmac_f32 v146, v169, v162
    v_fmac_f32 v147, v169, v163
    v_fmac_f32 v148, v169, v164
    v_fmac_f32 v149, v169, v165
    v_fmac_f32 v150, v169, v166
    v_fmac_f32 v151, v169, v167
    v_cvt_pk_bf16_f32 v216, -v144, -v145
    v_cvt_pk_bf16_f32 v217, -v146, -v147
    v_cvt_pk_bf16_f32 v218, -v148, -v149
    v_cvt_pk_bf16_f32 v219, -v150, -v151
    v_fmac_f32 v160, v168, v144
    v_fmac_f32 v161, v168, v145
    v_fmac_f32 v162, v168, v146
    v_fmac_f32 v163, v168, v147
    v_fmac_f32 v164, v168, v148
    v_fmac_f32 v165, v168, v149
    ds_read_b64_tr_b16 v[128:129], v153 offset:45056
    ds_read_b64_tr_b16 v[130:131], v153 offset:46080
    ds_read_b128 v[132:135], v152 offset:12288
    s_waitcnt lgkmcnt(12)
    v_mfma_f32_32x32x16_bf16 v[64:79], v[96:99], v[100:103], v[64:79]
    v_fmac_f32 v166, v168, v150
    v_fmac_f32 v167, v168, v151
    v_cvt_pk_bf16_f32 v220, -v160, -v161
    v_cvt_pk_bf16_f32 v221, -v162, -v163
    v_cvt_pk_bf16_f32 v222, -v164, -v165
    v_cvt_pk_bf16_f32 v223, -v166, -v167
    v_fmac_f32 v144, v169, v160
    v_fmac_f32 v145, v169, v161
    v_fmac_f32 v146, v169, v162
    v_fmac_f32 v147, v169, v163
    v_fmac_f32 v148, v169, v164
    v_fmac_f32 v149, v169, v165
    v_fmac_f32 v150, v169, v166
    v_fmac_f32 v151, v169, v167
    v_cvt_pk_bf16_f32 v224, v144, v145
    v_cvt_pk_bf16_f32 v225, v146, v147
    v_cvt_pk_bf16_f32 v226, v148, v149
    v_cvt_pk_bf16_f32 v227, v150, v151
    v_fmac_f32 v160, v168, v144
    v_fmac_f32 v161, v168, v145
    v_fmac_f32 v162, v168, v146
    v_fmac_f32 v163, v168, v147
    v_fmac_f32 v164, v168, v148
    v_fmac_f32 v165, v168, v149
    v_fmac_f32 v166, v168, v150
    v_fmac_f32 v167, v168, v151
    v_cvt_pk_bf16_f32 v228, v160, v161
    ds_read_b64_tr_b16 v[136:137], v153 offset:47104
    ds_read_b64_tr_b16 v[138:139], v153 offset:48128
    ds_read_b128 v[140:143], v152 offset:14336
    s_waitcnt lgkmcnt(12)
    v_mfma_f32_32x32x16_bf16 v[64:79], v[104:107], v[108:111], v[64:79]
    v_cvt_pk_bf16_f32 v229, v162, v163
    v_cvt_pk_bf16_f32 v230, v164, v165
    v_cvt_pk_bf16_f32 v231, v166, v167
    v_fmac_f32 v144, v169, v160
    v_fmac_f32 v145, v169, v161
    v_fmac_f32 v146, v169, v162
    v_fmac_f32 v147, v169, v163
    v_fmac_f32 v148, v169, v164
    v_fmac_f32 v149, v169, v165
    v_fmac_f32 v150, v169, v166
    v_fmac_f32 v151, v169, v167
    v_cvt_pk_bf16_f32 v232, -v144, -v145
    v_cvt_pk_bf16_f32 v233, -v146, -v147
    v_cvt_pk_bf16_f32 v234, -v148, -v149
    v_cvt_pk_bf16_f32 v235, -v150, -v151
    v_fmac_f32 v160, v168, v144
    v_fmac_f32 v161, v168, v145
    v_fmac_f32 v162, v168, v146
    v_fmac_f32 v163, v168, v147
    v_fmac_f32 v164, v168, v148
    v_fmac_f32 v165, v168, v149
    v_fmac_f32 v166, v168, v150
    v_fmac_f32 v167, v168, v151
    v_cvt_pk_bf16_f32 v236, -v160, -v161
    v_cvt_pk_bf16_f32 v237, -v162, -v163
    v_cvt_pk_bf16_f32 v238, -v164, -v165
    v_cvt_pk_bf16_f32 v239, -v166, -v167
    s_barrier
    ds_read_b64_tr_b16 v[80:81], v153 offset:49152
    ds_read_b64_tr_b16 v[82:83], v153 offset:50176
    ds_read_b128 v[84:87], v152 offset:16384
    s_waitcnt lgkmcnt(12)
    v_mfma_f32_32x32x16_bf16 v[64:79], v[112:115], v[116:119], v[64:79]
    ds_read_b64_tr_b16 v[88:89], v153 offset:51200
    ds_read_b64_tr_b16 v[90:91], v153 offset:52224
    ds_read_b128 v[92:95], v152 offset:18432
    s_waitcnt lgkmcnt(12)
    v_mfma_f32_32x32x16_bf16 v[64:79], v[120:123], v[124:127], v[64:79]
    ds_read_b64_tr_b16 v[96:97], v153 offset:53248
    ds_read_b64_tr_b16 v[98:99], v153 offset:54272
    ds_read_b128 v[100:103], v152 offset:20480
    s_waitcnt lgkmcnt(12)
    v_mfma_f32_32x32x16_bf16 v[64:79], v[128:131], v[132:135], v[64:79]
    ds_read_b64_tr_b16 v[104:105], v153 offset:55296
    ds_read_b64_tr_b16 v[106:107], v153 offset:56320
    ds_read_b128 v[108:111], v152 offset:22528
    s_waitcnt lgkmcnt(12)
    v_mfma_f32_32x32x16_bf16 v[64:79], v[136:139], v[140:143], v[64:79]
    s_waitcnt vmcnt(0)
    s_barrier
    ds_read_b64_tr_b16 v[112:113], v153 offset:57344
    ds_read_b64_tr_b16 v[114:115], v153 offset:58368
    ds_read_b128 v[116:119], v152 offset:32768
    s_waitcnt lgkmcnt(12)
    v_mfma_f32_32x32x16_bf16 v[64:79], v[80:83], v[84:87], v[64:79]
    ds_read_b64_tr_b16 v[120:121], v153 offset:59392
    ds_read_b64_tr_b16 v[122:123], v153 offset:60416
    ds_read_b128 v[124:127], v152 offset:34816
    s_waitcnt lgkmcnt(12)
    v_mfma_f32_32x32x16_bf16 v[64:79], v[88:91], v[92:95], v[64:79]
    ds_read_b64_tr_b16 v[128:129], v153 offset:61440
    ds_read_b64_tr_b16 v[130:131], v153 offset:62464
    ds_read_b128 v[132:135], v152 offset:36864
    s_waitcnt lgkmcnt(12)
    v_mfma_f32_32x32x16_bf16 v[64:79], v[96:99], v[100:103], v[64:79]
    ds_read_b64_tr_b16 v[136:137], v153 offset:63488
    ds_read_b64_tr_b16 v[138:139], v153 offset:64512
    ds_read_b128 v[140:143], v152 offset:38912
    s_waitcnt lgkmcnt(12)
    v_mfma_f32_32x32x16_bf16 v[64:79], v[104:107], v[108:111], v[64:79]
    s_barrier
    ds_read_b64_tr_b16 v[80:81], v154 offset:0
    ds_read_b64_tr_b16 v[82:83], v154 offset:1024
    ds_read_b128 v[84:87], v152 offset:40960
    s_waitcnt lgkmcnt(12)
    v_mfma_f32_32x32x16_bf16 v[64:79], v[112:115], v[116:119], v[64:79]
    ds_read_b64_tr_b16 v[88:89], v154 offset:2048
    ds_read_b64_tr_b16 v[90:91], v154 offset:3072
    ds_read_b128 v[92:95], v152 offset:43008
    s_waitcnt lgkmcnt(12)
    v_mfma_f32_32x32x16_bf16 v[64:79], v[120:123], v[124:127], v[64:79]
    ds_read_b64_tr_b16 v[96:97], v154 offset:4096
    ds_read_b64_tr_b16 v[98:99], v154 offset:5120
    ds_read_b128 v[100:103], v152 offset:45056
    s_waitcnt lgkmcnt(12)
    v_mfma_f32_32x32x16_bf16 v[64:79], v[128:131], v[132:135], v[64:79]
    ds_read_b64_tr_b16 v[104:105], v154 offset:6144
    ds_read_b64_tr_b16 v[106:107], v154 offset:7168
    ds_read_b128 v[108:111], v152 offset:47104
    s_waitcnt lgkmcnt(12)
    v_mfma_f32_32x32x16_bf16 v[64:79], v[136:139], v[140:143], v[64:79]
    s_barrier
    ds_read_b64_tr_b16 v[112:113], v154 offset:8192
    ds_read_b64_tr_b16 v[114:115], v154 offset:9216
    ds_read_b128 v[116:119], v152 offset:24576
    s_waitcnt lgkmcnt(12)
    v_mfma_f32_32x32x16_bf16 v[64:79], v[80:83], v[84:87], v[64:79]
    ds_read_b64_tr_b16 v[120:121], v154 offset:10240
    ds_read_b64_tr_b16 v[122:123], v154 offset:11264
    ds_read_b128 v[124:127], v152 offset:26624
    s_waitcnt lgkmcnt(12)
    v_mfma_f32_32x32x16_bf16 v[64:79], v[88:91], v[92:95], v[64:79]
    ds_read_b64_tr_b16 v[128:129], v154 offset:12288
    ds_read_b64_tr_b16 v[130:131], v154 offset:13312
    ds_read_b128 v[132:135], v152 offset:28672
    s_waitcnt lgkmcnt(12)
    v_mfma_f32_32x32x16_bf16 v[64:79], v[96:99], v[100:103], v[64:79]
    ds_read_b64_tr_b16 v[136:137], v154 offset:14336
    ds_read_b64_tr_b16 v[138:139], v154 offset:15360
    ds_read_b128 v[140:143], v152 offset:30720
    s_waitcnt lgkmcnt(12)
    v_mfma_f32_32x32x16_bf16 v[64:79], v[104:107], v[108:111], v[64:79]
    s_barrier
    ds_read_b64_tr_b16 v[80:81], v154 offset:16384
    ds_read_b64_tr_b16 v[82:83], v154 offset:17408
    ds_read_b128 v[84:87], v152 offset:0
    s_waitcnt lgkmcnt(12)
    v_mfma_f32_32x32x16_bf16 v[64:79], v[112:115], v[116:119], v[64:79]
    ds_read_b64_tr_b16 v[88:89], v154 offset:18432
    ds_read_b64_tr_b16 v[90:91], v154 offset:19456
    ds_read_b128 v[92:95], v152 offset:2048
    s_waitcnt lgkmcnt(12)
    v_mfma_f32_32x32x16_bf16 v[64:79], v[120:123], v[124:127], v[64:79]
    ds_read_b64_tr_b16 v[96:97], v154 offset:20480
    ds_read_b64_tr_b16 v[98:99], v154 offset:21504
    ds_read_b128 v[100:103], v152 offset:4096
    s_waitcnt lgkmcnt(12)
    v_mfma_f32_32x32x16_bf16 v[64:79], v[128:131], v[132:135], v[64:79]
    ds_read_b64_tr_b16 v[104:105], v154 offset:22528
    ds_read_b64_tr_b16 v[106:107], v154 offset:23552
    ds_read_b128 v[108:111], v152 offset:6144
    s_waitcnt lgkmcnt(12)
    v_mfma_f32_32x32x16_bf16 v[64:79], v[136:139], v[140:143], v[64:79]
    s_barrier
    ds_read_b64_tr_b16 v[112:113], v154 offset:24576
    ds_read_b64_tr_b16 v[114:115], v154 offset:25600
    ds_read_b128 v[116:119], v152 offset:8192
    s_waitcnt lgkmcnt(12)
    v_mfma_f32_32x32x16_bf16 v[64:79], v[80:83], v[84:87], v[64:79]
    ds_read_b64_tr_b16 v[120:121], v154 offset:26624
    ds_read_b64_tr_b16 v[122:123], v154 offset:27648
    ds_read_b128 v[124:127], v152 offset:10240
    s_waitcnt lgkmcnt(12)
    v_mfma_f32_32x32x16_bf16 v[64:79], v[88:91], v[92:95], v[64:79]
    ds_read_b64_tr_b16 v[128:129], v154 offset:28672
    ds_read_b64_tr_b16 v[130:131], v154 offset:29696
    ds_read_b128 v[132:135], v152 offset:12288
    s_waitcnt lgkmcnt(12)
    v_mfma_f32_32x32x16_bf16 v[64:79], v[96:99], v[100:103], v[64:79]
    ds_read_b64_tr_b16 v[136:137], v154 offset:30720
    ds_read_b64_tr_b16 v[138:139], v154 offset:31744
    ds_read_b128 v[140:143], v152 offset:14336
    s_waitcnt lgkmcnt(12)
    v_mfma_f32_32x32x16_bf16 v[64:79], v[104:107], v[108:111], v[64:79]
    s_barrier
    ds_read_b64_tr_b16 v[80:81], v154 offset:32768
    ds_read_b64_tr_b16 v[82:83], v154 offset:33792
    ds_read_b128 v[84:87], v152 offset:16384
    s_waitcnt lgkmcnt(12)
    v_mfma_f32_32x32x16_bf16 v[64:79], v[112:115], v[116:119], v[64:79]
    ds_read_b64_tr_b16 v[88:89], v154 offset:34816
    ds_read_b64_tr_b16 v[90:91], v154 offset:35840
    ds_read_b128 v[92:95], v152 offset:18432
    s_waitcnt lgkmcnt(12)
    v_mfma_f32_32x32x16_bf16 v[64:79], v[120:123], v[124:127], v[64:79]
    ds_read_b64_tr_b16 v[96:97], v154 offset:36864
    ds_read_b64_tr_b16 v[98:99], v154 offset:37888
    ds_read_b128 v[100:103], v152 offset:20480
    s_waitcnt lgkmcnt(12)
    v_mfma_f32_32x32x16_bf16 v[64:79], v[128:131], v[132:135], v[64:79]
    ds_read_b64_tr_b16 v[104:105], v154 offset:38912
    ds_read_b64_tr_b16 v[106:107], v154 offset:39936
    ds_read_b128 v[108:111], v152 offset:22528
    s_waitcnt lgkmcnt(12)
    v_mfma_f32_32x32x16_bf16 v[64:79], v[136:139], v[140:143], v[64:79]
    s_barrier
    ds_read_b64_tr_b16 v[112:113], v154 offset:40960
    ds_read_b64_tr_b16 v[114:115], v154 offset:41984
    ds_read_b128 v[116:119], v152 offset:32768
    s_waitcnt lgkmcnt(12)
    v_mfma_f32_32x32x16_bf16 v[64:79], v[80:83], v[84:87], v[64:79]
    ds_read_b64_tr_b16 v[120:121], v154 offset:43008
    ds_read_b64_tr_b16 v[122:123], v154 offset:44032
    ds_read_b128 v[124:127], v152 offset:34816
    s_waitcnt lgkmcnt(12)
    v_mfma_f32_32x32x16_bf16 v[64:79], v[88:91], v[92:95], v[64:79]
    ds_read_b64_tr_b16 v[128:129], v154 offset:45056
    ds_read_b64_tr_b16 v[130:131], v154 offset:46080
    ds_read_b128 v[132:135], v152 offset:36864
    s_waitcnt lgkmcnt(12)
    v_mfma_f32_32x32x16_bf16 v[64:79], v[96:99], v[100:103], v[64:79]
    ds_read_b64_tr_b16 v[136:137], v154 offset:47104
    ds_read_b64_tr_b16 v[138:139], v154 offset:48128
    ds_read_b128 v[140:143], v152 offset:38912
    s_waitcnt lgkmcnt(12)
    v_mfma_f32_32x32x16_bf16 v[64:79], v[104:107], v[108:111], v[64:79]
    s_barrier
    ds_read_b64_tr_b16 v[84:85], v155 offset:40960
    ds_read_b64_tr_b16 v[86:87], v155 offset:41472
    s_waitcnt lgkmcnt(11)
    v_mfma_f32_32x32x16_bf16 v[64:79], v[112:115], v[116:119], v[64:79]
    ds_read_b64_tr_b16 v[92:93], v155 offset:43008
    ds_read_b64_tr_b16 v[94:95], v155 offset:43520
    s_waitcnt lgkmcnt(10)
    v_mfma_f32_32x32x16_bf16 v[64:79], v[120:123], v[124:127], v[64:79]
    ds_read_b64_tr_b16 v[100:101], v155 offset:45056
    ds_read_b64_tr_b16 v[102:103], v155 offset:45568
    s_waitcnt lgkmcnt(9)
    v_mfma_f32_32x32x16_bf16 v[64:79], v[128:131], v[132:135], v[64:79]
    ds_read_b64_tr_b16 v[108:109], v155 offset:47104
    ds_read_b64_tr_b16 v[110:111], v155 offset:47616
    s_waitcnt lgkmcnt(8)
    v_mfma_f32_32x32x16_bf16 v[64:79], v[136:139], v[140:143], v[64:79]
    s_barrier
    v_and_b32 v173, 31, v170
    v_lshrrev_b32 v174, 5, v170
    s_lshl_b32 s14, s23, 2
    v_or_b32 v174, s14, v174
    v_and_b32 v156, 7, v170
    v_xor_b32 v174, v174, v156
    v_lshlrev_b32 v174, 4, v174
    v_lshl_add_u32 v158, v173, 7, v174
    s_lshl_b32 s14, s22, 12
    v_add_u32 v158, s14, v158
    v_lshrrev_b32 v173, 3, v170
    v_xor_b32 v174, v173, v156
    v_xor_b32 v156, 32, v158
    v_lshlrev_b32 v153, 4, v174
    v_bfe_u32 v174, v170, 5, 1
    v_lshl_add_u32 v153, v174, 20, v153
    v_bfe_u32 v174, v170, 3, 2
    v_lshl_add_u32 v153, v174, 16, v153
    s_lshl_b32 s14, s23, 19
    v_add_u32 v153, s14, v153
    v_add_u32 v154, 262144, v153
    s_lshl_b32 s14, s5, 11
    v_lshl_add_u32 v152, v170, 4, s14
    ds_read_b64_tr_b16 v[116:117], v155 offset:24576
    ds_read_b64_tr_b16 v[118:119], v155 offset:25088
    s_waitcnt lgkmcnt(8)
    v_mfma_f32_32x32x16_bf16 v[240:255], v[0:3], v[84:87], 0
    ds_read_b64_tr_b16 v[124:125], v155 offset:26624
    ds_read_b64_tr_b16 v[126:127], v155 offset:27136
    s_waitcnt lgkmcnt(8)
    v_mfma_f32_32x32x16_bf16 v[240:255], v[4:7], v[92:95], v[240:255]
    ds_read_b64_tr_b16 v[132:133], v155 offset:28672
    ds_read_b64_tr_b16 v[134:135], v155 offset:29184
    s_waitcnt lgkmcnt(8)
    v_mfma_f32_32x32x16_bf16 v[240:255], v[8:11], v[100:103], v[240:255]
    ds_read_b64_tr_b16 v[140:141], v155 offset:30720
    ds_read_b64_tr_b16 v[142:143], v155 offset:31232
    s_waitcnt lgkmcnt(8)
    v_mfma_f32_32x32x16_bf16 v[240:255], v[12:15], v[108:111], v[240:255]
    s_barrier
    ds_read_b64_tr_b16 v[84:85], v155 offset:0
    ds_read_b64_tr_b16 v[86:87], v155 offset:512
    s_waitcnt lgkmcnt(8)
    v_mfma_f32_32x32x16_bf16 v[240:255], v[16:19], v[116:119], v[240:255]
    ds_read_b64_tr_b16 v[92:93], v155 offset:2048
    ds_read_b64_tr_b16 v[94:95], v155 offset:2560
    s_waitcnt lgkmcnt(8)
    v_mfma_f32_32x32x16_bf16 v[240:255], v[20:23], v[124:127], v[240:255]
    ds_read_b64_tr_b16 v[100:101], v155 offset:4096
    ds_read_b64_tr_b16 v[102:103], v155 offset:4608
    s_waitcnt lgkmcnt(8)
    v_mfma_f32_32x32x16_bf16 v[240:255], v[24:27], v[132:135], v[240:255]
    ds_read_b64_tr_b16 v[108:109], v155 offset:6144
    ds_read_b64_tr_b16 v[110:111], v155 offset:6656
    s_waitcnt lgkmcnt(8)
    v_mfma_f32_32x32x16_bf16 v[240:255], v[28:31], v[140:143], v[240:255]
    s_barrier
    ds_read_b64_tr_b16 v[116:117], v155 offset:8192
    ds_read_b64_tr_b16 v[118:119], v155 offset:8704
    s_waitcnt lgkmcnt(8)
    v_mfma_f32_32x32x16_bf16 v[240:255], v[32:35], v[84:87], v[240:255]
    ds_read_b64_tr_b16 v[124:125], v155 offset:10240
    ds_read_b64_tr_b16 v[126:127], v155 offset:10752
    s_waitcnt lgkmcnt(8)
    v_mfma_f32_32x32x16_bf16 v[240:255], v[36:39], v[92:95], v[240:255]
    ds_read_b64_tr_b16 v[132:133], v155 offset:12288
    ds_read_b64_tr_b16 v[134:135], v155 offset:12800
    s_waitcnt lgkmcnt(8)
    v_mfma_f32_32x32x16_bf16 v[240:255], v[40:43], v[100:103], v[240:255]
    ds_read_b64_tr_b16 v[140:141], v155 offset:14336
    ds_read_b64_tr_b16 v[142:143], v155 offset:14848
    s_waitcnt lgkmcnt(8)
    v_mfma_f32_32x32x16_bf16 v[240:255], v[44:47], v[108:111], v[240:255]
    s_barrier
    s_xor_b32 s18, s18, 8192
    v_lshlrev_b32 v175, 4, v170
    s_lshl_b32 s13, s10, 1
    s_add_u32 s13, s13, s22
    s_lshl_b32 s14, s13, 7
    s_add_u32 s14, s14, 81920
    v_and_b32 v173, 31, v170
    v_lshlrev_b32 v173, 2, v173
    s_lshl_b32 s13, s13, 10
    s_lshl_b32 s15, s11, 7
    s_add_u32 s13, s13, s15
    ds_read_b64_tr_b16 v[84:85], v155 offset:16384
    ds_read_b64_tr_b16 v[86:87], v155 offset:16896
    s_waitcnt lgkmcnt(8)
    v_mfma_f32_32x32x16_bf16 v[240:255], v[48:51], v[116:119], v[240:255]
    buffer_load_dwordx4 v[144:147], v175, s[68:71], s18 offen offset:0 sc1
    ds_read_b64_tr_b16 v[92:93], v155 offset:18432
    ds_read_b64_tr_b16 v[94:95], v155 offset:18944
    s_waitcnt lgkmcnt(8)
    v_mfma_f32_32x32x16_bf16 v[240:255], v[52:55], v[124:127], v[240:255]
    buffer_load_dwordx4 v[148:151], v175, s[68:71], s18 offen offset:1024 sc1
    ds_read_b64_tr_b16 v[100:101], v155 offset:20480
    ds_read_b64_tr_b16 v[102:103], v155 offset:20992
    s_waitcnt lgkmcnt(8)
    v_mfma_f32_32x32x16_bf16 v[240:255], v[56:59], v[132:135], v[240:255]
    ds_read_b64_tr_b16 v[108:109], v155 offset:22528
    ds_read_b64_tr_b16 v[110:111], v155 offset:23040
    s_waitcnt lgkmcnt(8)
    v_mfma_f32_32x32x16_bf16 v[240:255], v[60:63], v[140:143], v[240:255]
    s_barrier
    ds_read_b64_tr_b16 v[116:117], v155 offset:32768
    ds_read_b64_tr_b16 v[118:119], v155 offset:33280
    s_waitcnt lgkmcnt(8)
    v_mfma_f32_32x32x16_bf16 v[240:255], v[176:179], v[84:87], v[240:255]
    buffer_load_dword v171, v173, s[68:71], s14 offen sc1
    ds_read_b64_tr_b16 v[124:125], v155 offset:34816
    ds_read_b64_tr_b16 v[126:127], v155 offset:35328
    s_waitcnt lgkmcnt(8)
    v_mfma_f32_32x32x16_bf16 v[240:255], v[180:183], v[92:95], v[240:255]
    ds_read_b64_tr_b16 v[132:133], v155 offset:36864
    ds_read_b64_tr_b16 v[134:135], v155 offset:37376
    s_waitcnt lgkmcnt(8)
    v_mfma_f32_32x32x16_bf16 v[240:255], v[184:187], v[100:103], v[240:255]
    ds_read_b64_tr_b16 v[140:141], v155 offset:38912
    ds_read_b64_tr_b16 v[142:143], v155 offset:39424
    s_waitcnt lgkmcnt(8)
    v_mfma_f32_32x32x16_bf16 v[240:255], v[188:191], v[108:111], v[240:255]
    s_barrier
    ds_read_b64_tr_b16 v[84:85], v155 offset:40960
    ds_read_b64_tr_b16 v[86:87], v155 offset:41472
    s_waitcnt lgkmcnt(8)
    v_mfma_f32_32x32x16_bf16 v[240:255], v[192:195], v[116:119], v[240:255]
    ds_read_b64_tr_b16 v[92:93], v155 offset:43008
    ds_read_b64_tr_b16 v[94:95], v155 offset:43520
    s_waitcnt lgkmcnt(8)
    v_mfma_f32_32x32x16_bf16 v[240:255], v[196:199], v[124:127], v[240:255]
    ds_read_b64_tr_b16 v[100:101], v155 offset:45056
    ds_read_b64_tr_b16 v[102:103], v155 offset:45568
    s_waitcnt lgkmcnt(8)
    v_mfma_f32_32x32x16_bf16 v[240:255], v[200:203], v[132:135], v[240:255]
    ds_read_b64_tr_b16 v[108:109], v155 offset:47104
    ds_read_b64_tr_b16 v[110:111], v155 offset:47616
    s_waitcnt lgkmcnt(8)
    v_mfma_f32_32x32x16_bf16 v[240:255], v[204:207], v[140:143], v[240:255]
    s_barrier
    ds_read_b64_tr_b16 v[116:117], v155 offset:24576
    ds_read_b64_tr_b16 v[118:119], v155 offset:25088
    s_waitcnt lgkmcnt(8)
    v_mfma_f32_32x32x16_bf16 v[240:255], v[208:211], v[84:87], v[240:255]
    ds_read_b64_tr_b16 v[124:125], v155 offset:26624
    ds_read_b64_tr_b16 v[126:127], v155 offset:27136
    s_waitcnt lgkmcnt(8)
    v_mfma_f32_32x32x16_bf16 v[240:255], v[212:215], v[92:95], v[240:255]
    ds_read_b64_tr_b16 v[132:133], v155 offset:28672
    ds_read_b64_tr_b16 v[134:135], v155 offset:29184
    s_waitcnt lgkmcnt(8)
    v_mfma_f32_32x32x16_bf16 v[240:255], v[216:219], v[100:103], v[240:255]
    ds_read_b64_tr_b16 v[140:141], v155 offset:30720
    ds_read_b64_tr_b16 v[142:143], v155 offset:31232
    s_waitcnt lgkmcnt(8)
    v_mfma_f32_32x32x16_bf16 v[240:255], v[220:223], v[108:111], v[240:255]
    s_waitcnt lgkmcnt(6)
    v_mfma_f32_32x32x16_bf16 v[240:255], v[224:227], v[116:119], v[240:255]
    s_waitcnt vmcnt(0)
    v_sub_f32 v160, 1.0, v171
    v_mul_f32 v162, 0x36000000, v171
    v_lshlrev_b32 v164, 16, v144
    v_and_b32 v165, 0xffff0000, v144
    v_add_f32 v64, v64, v164
    v_add_f32 v65, v65, v165
    v_mul_f32 v64, v160, v64
    v_mul_f32 v65, v160, v65
    v_lshlrev_b32 v164, 16, v145
    v_and_b32 v165, 0xffff0000, v145
    v_add_f32 v66, v66, v164
    v_add_f32 v67, v67, v165
    v_mul_f32 v66, v160, v66
    v_mul_f32 v67, v160, v67
    s_waitcnt lgkmcnt(4)
    v_mfma_f32_32x32x16_bf16 v[240:255], v[228:231], v[124:127], v[240:255]
    v_lshlrev_b32 v164, 16, v146
    v_and_b32 v165, 0xffff0000, v146
    v_add_f32 v68, v68, v164
    v_add_f32 v69, v69, v165
    v_mul_f32 v68, v160, v68
    v_mul_f32 v69, v160, v69
    v_lshlrev_b32 v164, 16, v147
    v_and_b32 v165, 0xffff0000, v147
    v_add_f32 v70, v70, v164
    v_add_f32 v71, v71, v165
    v_mul_f32 v70, v160, v70
    v_mul_f32 v71, v160, v71
    s_waitcnt lgkmcnt(2)
    v_mfma_f32_32x32x16_bf16 v[240:255], v[232:235], v[132:135], v[240:255]
    v_lshlrev_b32 v164, 16, v148
    v_and_b32 v165, 0xffff0000, v148
    v_add_f32 v72, v72, v164
    v_add_f32 v73, v73, v165
    v_mul_f32 v72, v160, v72
    v_mul_f32 v73, v160, v73
    v_lshlrev_b32 v164, 16, v149
    v_and_b32 v165, 0xffff0000, v149
    v_add_f32 v74, v74, v164
    v_add_f32 v75, v75, v165
    v_mul_f32 v74, v160, v74
    v_mul_f32 v75, v160, v75
    s_waitcnt lgkmcnt(0)
    v_mfma_f32_32x32x16_bf16 v[240:255], v[236:239], v[140:143], v[240:255]
    v_lshlrev_b32 v164, 16, v150
    v_and_b32 v165, 0xffff0000, v150
    v_add_f32 v76, v76, v164
    v_add_f32 v77, v77, v165
    v_mul_f32 v76, v160, v76
    v_mul_f32 v77, v160, v77
    v_lshlrev_b32 v164, 16, v151
    v_and_b32 v165, 0xffff0000, v151
    v_add_f32 v78, v78, v164
    v_add_f32 v79, v79, v165
    v_mul_f32 v78, v160, v78
    v_mul_f32 v79, v160, v79
    v_pk_fma_f32 v[64:65], v[240:241], v[162:163], v[64:65] op_sel_hi:[1,0,1]
    v_pk_fma_f32 v[66:67], v[242:243], v[162:163], v[66:67] op_sel_hi:[1,0,1]
    v_pk_fma_f32 v[68:69], v[244:245], v[162:163], v[68:69] op_sel_hi:[1,0,1]
    v_pk_fma_f32 v[70:71], v[246:247], v[162:163], v[70:71] op_sel_hi:[1,0,1]
    v_pk_fma_f32 v[72:73], v[248:249], v[162:163], v[72:73] op_sel_hi:[1,0,1]
    v_pk_fma_f32 v[74:75], v[250:251], v[162:163], v[74:75] op_sel_hi:[1,0,1]
    v_pk_fma_f32 v[76:77], v[252:253], v[162:163], v[76:77] op_sel_hi:[1,0,1]
    v_pk_fma_f32 v[78:79], v[254:255], v[162:163], v[78:79] op_sel_hi:[1,0,1]
    v_cvt_pk_bf16_f32 v80, v64, v65
    v_cvt_pk_bf16_f32 v81, v66, v67
    v_cvt_pk_bf16_f32 v82, v68, v69
    v_cvt_pk_bf16_f32 v83, v70, v71
    v_cvt_pk_bf16_f32 v84, v72, v73
    v_cvt_pk_bf16_f32 v85, v74, v75
    v_cvt_pk_bf16_f32 v86, v76, v77
    v_cvt_pk_bf16_f32 v87, v78, v79
    v_permlane32_swap_b32 v80, v82
    v_permlane32_swap_b32 v81, v83
    v_permlane32_swap_b32 v84, v86
    v_permlane32_swap_b32 v85, v87
    ds_write_b128 v158, v[80:83]
    ds_write_b128 v156, v[84:87]
    s_waitcnt lgkmcnt(0)
    s_barrier
    ds_read_b128 v[88:91], v152 offset:0
    ds_read_b128 v[92:95], v152 offset:1024
    s_waitcnt lgkmcnt(1)
    buffer_store_dwordx4 v[88:91], v153, s[60:63], s13 offen nt
    s_waitcnt lgkmcnt(0)
    buffer_store_dwordx4 v[92:95], v154, s[60:63], s13 offen nt
L_end:
    s_endpgm
L_fconst:
    s_nop 0
    v_and_b32 v94, 15, v170
    v_cvt_f32_u32 v94, v94
    v_lshrrev_b32 v95, 4, v170
    v_lshlrev_b32 v95, 2, v95
    v_cvt_f32_u32 v95, v95
    s_lshl_b32 s15, s5, 4
    v_cvt_f32_u32 v90, s15
    v_add_f32 v80, 0x00000000, v94
    v_mul_f32 v80, 0x3d000000, v80
    v_mul_f32 v96, v95, v80
    v_mul_f32 v81, 0x41800000, v80
    v_add_f32 v97, v96, v80
    v_add_f32 v98, v97, v80
    v_add_f32 v99, v98, v80
    v_add_f32 v100, v96, v81
    v_add_f32 v101, v97, v81
    v_add_f32 v102, v98, v81
    v_add_f32 v103, v99, v81
    v_cos_f32 v104, v96
    v_cos_f32 v105, v97
    v_cos_f32 v106, v98
    v_cos_f32 v107, v99
    v_cos_f32 v108, v100
    v_cos_f32 v109, v101
    v_cos_f32 v110, v102
    v_cos_f32 v111, v103
    v_sin_f32 v112, v96
    v_sin_f32 v113, v97
    v_sin_f32 v114, v98
    v_sin_f32 v115, v99
    v_sin_f32 v116, v100
    v_sin_f32 v117, v101
    v_sin_f32 v118, v102
    v_sin_f32 v119, v103
    v_cvt_pk_bf16_f32 v176, v104, v105
    v_cvt_pk_bf16_f32 v184, v112, v113
    v_xor_b32 v192, 0x80008000, v184
    v_cvt_pk_bf16_f32 v177, v106, v107
    v_cvt_pk_bf16_f32 v185, v114, v115
    v_xor_b32 v193, 0x80008000, v185
    v_cvt_pk_bf16_f32 v178, v108, v109
    v_cvt_pk_bf16_f32 v186, v116, v117
    v_xor_b32 v194, 0x80008000, v186
    v_cvt_pk_bf16_f32 v179, v110, v111
    v_cvt_pk_bf16_f32 v187, v118, v119
    v_xor_b32 v195, 0x80008000, v187
    v_add_f32 v80, 0x41800000, v94
    v_mul_f32 v80, 0x3d000000, v80
    v_mul_f32 v96, v95, v80
    v_mul_f32 v81, 0x41800000, v80
    v_add_f32 v97, v96, v80
    v_add_f32 v98, v97, v80
    v_add_f32 v99, v98, v80
    v_add_f32 v100, v96, v81
    v_add_f32 v101, v97, v81
    v_add_f32 v102, v98, v81
    v_add_f32 v103, v99, v81
    v_cos_f32 v104, v96
    v_cos_f32 v105, v97
    v_cos_f32 v106, v98
    v_cos_f32 v107, v99
    v_cos_f32 v108, v100
    v_cos_f32 v109, v101
    v_cos_f32 v110, v102
    v_cos_f32 v111, v103
    v_sin_f32 v112, v96
    v_sin_f32 v113, v97
    v_sin_f32 v114, v98
    v_sin_f32 v115, v99
    v_sin_f32 v116, v100
    v_sin_f32 v117, v101
    v_sin_f32 v118, v102
    v_sin_f32 v119, v103
    v_cvt_pk_bf16_f32 v180, v104, v105
    v_cvt_pk_bf16_f32 v188, v112, v113
    v_xor_b32 v196, 0x80008000, v188
    v_cvt_pk_bf16_f32 v181, v106, v107
    v_cvt_pk_bf16_f32 v189, v114, v115
    v_xor_b32 v197, 0x80008000, v189
    v_cvt_pk_bf16_f32 v182, v108, v109
    v_cvt_pk_bf16_f32 v190, v116, v117
    v_xor_b32 v198, 0x80008000, v190
    v_cvt_pk_bf16_f32 v183, v110, v111
    v_cvt_pk_bf16_f32 v191, v118, v119
    v_xor_b32 v199, 0x80008000, v191
    v_add_f32 v82, v90, v94
    v_mul_f32 v80, 0x3c800000, v82
    v_mul_f32 v81, 0x41800000, v80
    v_mul_f32 v96, v95, v80
    v_add_f32 v97, v96, v80
    v_add_f32 v98, v97, v80
    v_add_f32 v99, v98, v80
    v_mul_f32 v84, v90, v80
    v_add_f32 v96, v96, v84
    v_add_f32 v97, v97, v84
    v_add_f32 v98, v98, v84
    v_add_f32 v99, v99, v84
    v_cos_f32 v104, v96
    v_cos_f32 v105, v97
    v_cos_f32 v106, v98
    v_cos_f32 v107, v99
    v_sin_f32 v112, v96
    v_sin_f32 v113, v97
    v_sin_f32 v114, v98
    v_sin_f32 v115, v99
    v_cvt_pk_bf16_f32 v202, v104, v105
    v_cvt_pk_bf16_f32 v204, v112, v113
    v_xor_b32 v200, 0x80008000, v204
    v_cvt_pk_bf16_f32 v203, v106, v107
    v_cvt_pk_bf16_f32 v205, v114, v115
    v_xor_b32 v201, 0x80008000, v205
    v_add_f32 v96, v96, v81
    v_add_f32 v97, v97, v81
    v_add_f32 v98, v98, v81
    v_add_f32 v99, v99, v81
    v_cos_f32 v104, v96
    v_cos_f32 v105, v97
    v_cos_f32 v106, v98
    v_cos_f32 v107, v99
    v_sin_f32 v112, v96
    v_sin_f32 v113, v97
    v_sin_f32 v114, v98
    v_sin_f32 v115, v99
    v_cvt_pk_bf16_f32 v208, v104, v105
    v_cvt_pk_bf16_f32 v210, v112, v113
    v_xor_b32 v206, 0x80008000, v210
    v_cvt_pk_bf16_f32 v209, v106, v107
    v_cvt_pk_bf16_f32 v211, v114, v115
    v_xor_b32 v207, 0x80008000, v211
    v_add_f32 v96, v96, v81
    v_add_f32 v97, v97, v81
    v_add_f32 v98, v98, v81
    v_add_f32 v99, v99, v81
    v_cos_f32 v104, v96
    v_cos_f32 v105, v97
    v_cos_f32 v106, v98
    v_cos_f32 v107, v99
    v_sin_f32 v112, v96
    v_sin_f32 v113, v97
    v_sin_f32 v114, v98
    v_sin_f32 v115, v99
    v_cvt_pk_bf16_f32 v214, v104, v105
    v_cvt_pk_bf16_f32 v216, v112, v113
    v_xor_b32 v212, 0x80008000, v216
    v_cvt_pk_bf16_f32 v215, v106, v107
    v_cvt_pk_bf16_f32 v217, v114, v115
    v_xor_b32 v213, 0x80008000, v217
    v_add_f32 v96, v96, v81
    v_add_f32 v97, v97, v81
    v_add_f32 v98, v98, v81
    v_add_f32 v99, v99, v81
    v_cos_f32 v104, v96
    v_cos_f32 v105, v97
    v_cos_f32 v106, v98
    v_cos_f32 v107, v99
    v_sin_f32 v112, v96
    v_sin_f32 v113, v97
    v_sin_f32 v114, v98
    v_sin_f32 v115, v99
    v_cvt_pk_bf16_f32 v220, v104, v105
    v_cvt_pk_bf16_f32 v222, v112, v113
    v_xor_b32 v218, 0x80008000, v222
    v_cvt_pk_bf16_f32 v221, v106, v107
    v_cvt_pk_bf16_f32 v223, v114, v115
    v_xor_b32 v219, 0x80008000, v223
    v_add_f32 v83, v90, v95
    v_add_f32 v80, 0x00000000, v94
    v_mul_f32 v80, 0x3a000000, v80
    v_mul_f32 v96, v83, v80
    v_add_f32 v97, v96, v80
    v_add_f32 v98, v97, v80
    v_add_f32 v99, v98, v80
    v_add_f32 v80, 0x41800000, v94
    v_mul_f32 v80, 0x3a000000, v80
    v_mul_f32 v100, v83, v80
    v_add_f32 v101, v100, v80
    v_add_f32 v102, v101, v80
    v_add_f32 v103, v102, v80
    v_cos_f32 v224, v96
    v_cos_f32 v225, v97
    v_cos_f32 v226, v98
    v_cos_f32 v227, v99
    v_cos_f32 v228, v100
    v_cos_f32 v229, v101
    v_cos_f32 v230, v102
    v_cos_f32 v231, v103
    v_sin_f32 v232, v96
    v_sin_f32 v233, v97
    v_sin_f32 v234, v98
    v_sin_f32 v235, v99
    v_sin_f32 v236, v100
    v_sin_f32 v237, v101
    v_sin_f32 v238, v102
    v_sin_f32 v239, v103
    v_mul_f32 v80, 0x3a000000, v82
    v_mul_f32 v81, 0x41800000, v80
    v_mul_f32 v96, v95, v80
    v_add_f32 v97, v96, v80
    v_add_f32 v98, v97, v80
    v_add_f32 v99, v98, v80
    v_add_f32 v100, v96, v81
    v_add_f32 v101, v97, v81
    v_add_f32 v102, v98, v81
    v_add_f32 v103, v99, v81
    v_cos_f32 v240, v96
    v_cos_f32 v241, v97
    v_cos_f32 v242, v98
    v_cos_f32 v243, v99
    v_cos_f32 v244, v100
    v_cos_f32 v245, v101
    v_cos_f32 v246, v102
    v_cos_f32 v247, v103
    v_sin_f32 v248, v96
    v_sin_f32 v249, v97
    v_sin_f32 v250, v98
    v_sin_f32 v251, v99
    v_sin_f32 v252, v100
    v_sin_f32 v253, v101
    v_sin_f32 v254, v102
    v_sin_f32 v255, v103
    v_and_b32 v80, 15, v170
    v_lshrrev_b32 v81, 4, v170
    v_lshlrev_b32 v161, 4, v170
    s_lshl_b32 s15, s5, 11
    s_add_u32 s15, s15, 147456
    v_add_u32 v162, s15, v161
    v_lshlrev_b32 v164, 6, v80
    v_lshl_add_u32 v164, v81, 4, v164
    s_nop 0
    s_setpc_b64 s[26:27]
L_codeend:
.section .rodata,"a"
.p2align 6
.amdhsa_kernel gated_mix__spectral_gfnet__dense_activation_gelu__prompt_kernel
  .amdhsa_next_free_vgpr 256
  .amdhsa_next_free_sgpr 102
  .amdhsa_accum_offset 256
  .amdhsa_group_segment_fixed_size 0
  .amdhsa_kernarg_size 96
  .amdhsa_user_sgpr_count 2
  .amdhsa_user_sgpr_kernarg_segment_ptr 1
  .amdhsa_system_sgpr_workgroup_id_x 1
  .amdhsa_float_denorm_mode_32 3
.end_amdhsa_kernel
```
